```python
import torch

def _softmax(x, axis=-1):
    return torch.softmax(x, dim=axis)
def _gelu(x):
    return torch.nn.functional.gelu(x, approximate="tanh")
def _silu(x):
    return torch.nn.functional.silu(x)
def _sigmoid(x):
    return torch.sigmoid(x)
def _layernorm(x, axis=-1, eps=1e-5):
    m = x.mean(dim=axis, keepdim=True)
    v = x.var(dim=axis, keepdim=True, unbiased=False)
    return (x - m) / torch.sqrt(v + eps)
def _scatter_add(tgt, idx, src, axis=0):
    return tgt.clone().index_add_(axis, idx, src)
def _segment_sum(src, seg, n):
    out = torch.zeros((n,) + src.shape[1:], dtype=src.dtype)
    return out.index_add_(0, seg, src)
def _pad(x, pw):
    flat = tuple(v for pair in reversed(pw) for v in pair)
    return torch.nn.functional.pad(x, flat)

kernel_name = 'gated_mix__grouped_kv_mqa__mha_block__prompt'

def setup_inputs():

    _w = (lambda a: (lambda t: t.to(torch.bfloat16) if t.is_floating_point() else t)(torch.as_tensor(a)))
    def _A_setup():
        B, S, D, H = 1, 2048, 640, 32
        Dh = D // H
        return {
            "x": _w((lambda *s: torch.randn(*s, dtype=torch.bfloat16) * 0.1)(B, S, D)),
            "wq": _w((lambda *s: torch.randn(*s, dtype=torch.bfloat16) * 0.4)(D, H * Dh)),
            "wk": _w((lambda *s: torch.randn(*s, dtype=torch.bfloat16) * 0.4)(D, Dh)),
            "wv": _w((lambda *s: torch.randn(*s, dtype=torch.bfloat16) * 0.4)(D, Dh)),
            "wo": _w((lambda *s: torch.randn(*s, dtype=torch.bfloat16) * 0.4)(H * Dh, D)),
        }
    _A_in = _A_setup()

    def _B_setup():
        B, S, D, H = 1, 2048, 640, 32
        return {
            "x": _w((lambda *s: torch.randn(*s, dtype=torch.bfloat16) * 0.1)(B, S, D)),
            "wqkv": _w((lambda *s: torch.randn(*s, dtype=torch.bfloat16) * 0.4)(D, 3 * D)),
            "wo": _w((lambda *s: torch.randn(*s, dtype=torch.bfloat16) * 0.2)(D, D)),
        }
    _B_in = _B_setup()

    return {
        "A_x": _A_in["x"],
        "A_wq": _A_in["wq"],
        "A_wk": _A_in["wk"],
        "A_wv": _A_in["wv"],
        "A_wo": _A_in["wo"],
        "B_x": _B_in["x"],
        "B_wqkv": _B_in["wqkv"],
        "B_wo": _B_in["wo"],
        "gate_w": _w((lambda *s: torch.randn(*s, dtype=torch.bfloat16) * 0.1)(640) * 16.0),
    }

def reference(A_x, A_wq, A_wk, A_wv, A_wo, B_x, B_wqkv, B_wo, gate_w):
    def _A_ref(x, wq, wk, wv, wo):
        B, S, D = x.shape
        H = 32
        Dh = D // H
        q = (lambda x, *d: x.permute(*d))((x @ wq).reshape(B, S, H, Dh), 0, 2, 1, 3)
        k = x @ wk
        v = x @ wv
        scores = torch.einsum("bhqd,bkd->bhqk", q, k) * (Dh ** -0.5)
        p = _softmax(scores, axis=-1)
        o = torch.einsum("bhqk,bkd->bhqd", p, v)
        return (lambda x, *d: x.permute(*d))(o, 0, 2, 1, 3).reshape(B, S, H * Dh) @ wo

    def _B_ref(x, wqkv, wo):
        B, S, D = x.shape
        H = 32
        Dh = D // H
        qkv = (lambda x, *d: x.permute(*d))((x @ wqkv).reshape(B, S, 3, H, Dh), 2, 0, 3, 1, 4)
        q, k, v = qkv[0], qkv[1], qkv[2]
        scores = torch.einsum("bhqd,bhkd->bhqk", q, k) * (Dh ** -0.5)
        p = _softmax(scores, axis=-1)
        o = torch.einsum("bhqk,bhkd->bhqd", p, v)
        return (lambda x, *d: x.permute(*d))(o, 0, 2, 1, 3).reshape(B, S, D) @ wo

    x = A_x
    g = _sigmoid((x * gate_w).sum(-1, keepdims=True))
    a = _A_ref(x, A_wq, A_wk, A_wv, A_wo)
    b = _B_ref(x, B_wqkv, B_wo)
    return g * a + (1 - g) * b
```

```asm
; @launch kernel=proj_kernel grid=(256,1,1) block=(512,1,1) lds=163840
; @launch kernel=attn_kernel grid=(256,1,1) block=(1024,1,1) lds=163840
; @launch kernel=out_kernel grid=(256,1,1) block=(256,1,1) lds=61440
.amdgcn_target "amdgcn-amd-amdhsa--gfx950"
.text
.globl proj_kernel
.p2align 8
.type proj_kernel,@function
proj_kernel:
  s_cmp_ge_u32 s2, 256
  s_cbranch_scc1 Lproj_end
  s_load_dwordx4 s[52:55], s[0:1], 0
  s_load_dwordx4 s[56:59], s[0:1], 16
  s_load_dwordx2 s[60:61], s[0:1], 48
  s_load_dwordx2 s[62:63], s[0:1], 64
  s_load_dwordx2 s[4:5], s[0:1], 88
  v_and_b32 v1, 63, v0
  v_lshrrev_b32 v18, 6, v0
  v_and_b32 v21, 31, v0
  v_readfirstlane_b32 s26, v18
  v_lshrrev_b32 v22, 5, v1
  s_and_b32 s46, s2, 7
  s_lshr_b32 s47, s2, 3
  s_and_b32 s24, s46, 1
  s_lshl_b32 s24, s24, 3
  s_and_b32 s48, s47, 7
  s_add_u32 s24, s24, s48
  s_lshr_b32 s25, s46, 1
  s_lshl_b32 s25, s25, 2
  s_lshr_b32 s47, s47, 3
  s_add_u32 s25, s25, s47
  s_mov_b32 s74, s25
  s_cmp_lt_u32 s25, 4
  s_movk_i32 s27, 3840
  s_cselect_b32 s27, 1280, s27
  s_cselect_b32 s46, 0, 4
  s_sub_u32 s46, s25, s46
  s_mul_i32 s29, s46, 320
  s_lshl_b32 s31, s27, 6
  s_mul_i32 s28, s24, 163840
  s_mov_b32 s30, 0
  s_lshl_b32 s46, s26, 4
  v_lshrrev_b32 v18, 3, v1
  v_add_u32 v18, s46, v18
  v_and_b32 v19, 7, v1
  v_bfe_u32 v20, v18, 1, 3
  v_xor_b32 v20, v20, v19
  v_lshlrev_b32 v20, 4, v20
  v_mul_u32_u24 v2, 1280, v18
  v_add_u32 v2, v2, v20
  v_add_u32 v18, 8, v18
  v_bfe_u32 v20, v18, 1, 3
  v_xor_b32 v20, v20, v19
  v_lshlrev_b32 v20, 4, v20
  v_mul_u32_u24 v3, 1280, v18
  v_add_u32 v3, v3, v20
  s_lshl_b32 s41, s26, 11
  s_add_u32 s42, s41, 1024
  s_mul_i32 s46, s26, 3
  s_lshl_b32 s47, s26, 1
  s_add_u32 s47, s47, 4
  s_cmp_lt_u32 s26, 4
  s_cselect_b32 s46, s46, s47
  s_lshl_b32 s47, s46, 6
  v_add_u32 v18, s47, v1
  s_lshl_b32 s46, s46, 10
  v_mul_u32_u24 v19, 3277, v18
  v_lshrrev_b32 v19, 16, v19
  v_mul_u32_u24 v20, 20, v19
  v_sub_u32 v20, v18, v20
  v_lshlrev_b32 v20, 4, v20
  v_mul_lo_u32 v4, v19, s27
  v_add_u32 v4, v4, v20
  s_add_u32 s43, s46, 16384
  v_add_u32 v18, 64, v18
  v_mul_u32_u24 v19, 3277, v18
  v_lshrrev_b32 v19, 16, v19
  v_mul_u32_u24 v20, 20, v19
  v_sub_u32 v20, v18, v20
  v_lshlrev_b32 v20, 4, v20
  v_mul_lo_u32 v5, v19, s27
  v_add_u32 v5, v5, v20
  s_add_u32 s44, s46, 17408
  v_add_u32 v18, 64, v18
  v_mul_u32_u24 v19, 3277, v18
  v_lshrrev_b32 v19, 16, v19
  v_mul_u32_u24 v20, 20, v19
  v_sub_u32 v20, v18, v20
  v_lshlrev_b32 v20, 4, v20
  v_mul_lo_u32 v6, v19, s27
  v_add_u32 v6, v6, v20
  s_add_u32 s45, s46, 18432
  s_cmp_lt_u32 s26, 4
  s_cbranch_scc1 Lproj_noE
  s_sub_u32 s46, s26, 4
  s_lshl_b32 s46, s46, 10
  v_lshlrev_b32 v6, 4, v1
  v_add_u32 v6, s46, v6
  s_add_u32 s45, s46, 36864
  s_cmp_eq_u32 s74, 2
  s_movk_i32 s46, 2560
  s_cselect_b32 s46, 128, s46
  v_cmp_le_u32 vcc, s46, v6
  v_mov_b32 v18, 0x40000000
  s_nop 0
  v_cndmask_b32 v6, v6, v18, vcc
Lproj_noE:
  s_cmp_eq_u32 s74, 2
  s_movk_i32 s32, 2560
  s_cselect_b32 s32, 128, s32
  s_waitcnt lgkmcnt(0)
  s_mov_b32 s8, s52
  s_mov_b32 s9, s53
  s_mov_b32 s10, 2621440
  s_mov_b32 s11, 0x00020000
  s_cmp_lt_u32 s25, 4
  s_cselect_b32 s12, s54, s60
  s_cselect_b32 s13, s55, s61
  s_mov_b32 s14, 2457600
  s_cselect_b32 s14, 819200, s14
  s_mov_b32 s15, 0x00020000
  s_cmp_eq_u32 s74, 1
  s_cselect_b32 s16, s58, s56
  s_cselect_b32 s17, s59, s57
  s_mov_b32 s18, 25600
  s_cmp_eq_u32 s74, 2
  s_cselect_b32 s16, s62, s16
  s_cselect_b32 s17, s63, s17
  s_cselect_b32 s18, 1280, s18
  s_cmp_gt_u32 s74, 2
  s_cselect_b32 s18, 0, s18
  s_mov_b32 s19, 0x00020000
  s_mov_b32 s20, s4
  s_mov_b32 s21, s5
  s_mov_b32 s22, 18415616
  s_mov_b32 s23, 0x00020000
  s_mov_b32 s33, 0
  s_and_b32 s6, s25, 7
  s_and_b32 s46, s24, 3
  s_mul_i32 s46, s46, 3
  s_add_u32 s6, s6, s46
  s_cmp_ge_u32 s6, 10
  s_cselect_b32 s46, 10, 0
  s_sub_u32 s6, s6, s46
  s_mov_b32 s6, 0
  s_mov_b32 s7, s6
  s_lshl_b32 s46, s6, 7
  s_add_u32 s28, s28, s46
  s_mul_i32 s46, s6, s31
  s_add_u32 s29, s29, s46
  s_mul_i32 s30, s6, s32
  s_mul_i32 s51, s31, -9
  s_mul_i32 s3, s32, -9
  s_mov_b32 s67, 0x00020000
  s_cmp_lt_u32 s26, 3
  s_cbranch_scc1 Lproj_tlb
  s_mov_b32 s64, s52
  s_mov_b32 s65, s53
  s_movk_i32 s68, 80
  s_mov_b32 s69, 0
  s_movk_i32 s70, 64
  s_cmp_eq_u32 s26, 4
  s_cselect_b32 s69, 64, s69
  s_cselect_b32 s70, 16, s70
  s_cmp_eq_u32 s26, 5
  s_cselect_b32 s64, s54, s64
  s_cselect_b32 s65, s55, s65
  s_cselect_b32 s68, 25, s68
  s_cselect_b32 s70, 25, s70
  s_cmp_ge_u32 s26, 6
  s_cselect_b32 s64, s60, s64
  s_cselect_b32 s65, s61, s65
  s_cselect_b32 s68, 75, s68
  s_cmp_eq_u32 s26, 7
  s_cselect_b32 s69, 64, s69
  s_cselect_b32 s70, 11, s70
  s_mul_i32 s68, s68, s2
  s_add_u32 s68, s68, s69
  s_add_u32 s66, s68, s70
  s_lshl_b32 s66, s66, 7
  s_lshl_b32 s68, s68, 7
  v_lshlrev_b32 v18, 7, v1
  buffer_load_dword v31, v18, s[64:67], s68 offen
  s_branch Lproj_nopfx
Lproj_tlb:
Lproj_nopfx:
  s_movk_i32 s52, 128
  s_cmp_lt_u32 s26, 4
  s_cbranch_scc0 Lproj_pre1
  s_add_u32 m0, s41, s33
  s_nop 0
  buffer_load_dwordx4 v2, s[8:11], s28 offen lds
  s_add_u32 m0, s42, s33
  s_add_u32 s6, s6, 1
  buffer_load_dwordx4 v3, s[8:11], s28 offen lds
  s_cmp_eq_u32 s6, 10
  s_cselect_b32 s46, -1152, s52
  s_cselect_b32 s6, 0, s6
  s_add_u32 s28, s28, s46
  s_add_u32 m0, s43, s33
  s_nop 0
  buffer_load_dwordx4 v4, s[12:15], s29 offen lds
  s_add_u32 m0, s44, s33
  s_nop 0
  buffer_load_dwordx4 v5, s[12:15], s29 offen lds
  s_add_u32 m0, s45, s33
  s_add_u32 s7, s7, 1
  buffer_load_dwordx4 v6, s[12:15], s29 offen lds
  s_cmp_eq_u32 s7, 10
  s_cselect_b32 s46, s51, s31
  s_cselect_b32 s47, s3, s32
  s_cselect_b32 s7, 0, s7
  s_add_u32 s29, s29, s46
  s_add_u32 s33, s33, 40960
  s_cmp_eq_u32 s33, 163840
  s_cselect_b32 s33, 0, s33
  s_branch Lproj_pre2
Lproj_pre1:
  s_add_u32 m0, s41, s33
  s_nop 0
  buffer_load_dwordx4 v2, s[8:11], s28 offen lds
  s_add_u32 m0, s42, s33
  s_add_u32 s6, s6, 1
  buffer_load_dwordx4 v3, s[8:11], s28 offen lds
  s_cmp_eq_u32 s6, 10
  s_cselect_b32 s46, -1152, s52
  s_cselect_b32 s6, 0, s6
  s_add_u32 s28, s28, s46
  s_add_u32 m0, s43, s33
  s_nop 0
  buffer_load_dwordx4 v4, s[12:15], s29 offen lds
  s_add_u32 m0, s44, s33
  s_nop 0
  buffer_load_dwordx4 v5, s[12:15], s29 offen lds
  s_add_u32 m0, s45, s33
  s_add_u32 s7, s7, 1
  buffer_load_dwordx4 v6, s[16:19], s30 offen lds
  s_cmp_eq_u32 s7, 10
  s_cselect_b32 s46, s51, s31
  s_cselect_b32 s47, s3, s32
  s_cselect_b32 s7, 0, s7
  s_add_u32 s29, s29, s46
  s_add_u32 s30, s30, s47
  s_add_u32 s33, s33, 40960
  s_cmp_eq_u32 s33, 163840
  s_cselect_b32 s33, 0, s33
Lproj_pre2:
  s_and_b32 s46, s26, 3
  s_lshl_b32 s36, s24, 2
  s_add_u32 s36, s36, s46
  s_lshl_b32 s46, s46, 12
  v_bfe_u32 v18, v21, 1, 3
  v_xor_b32 v18, v18, v22
  v_lshlrev_b32 v18, 4, v18
  v_lshlrev_b32 v7, 7, v21
  v_add_u32 v7, v7, v18
  v_add_u32 v7, s46, v7
  v_bfe_u32 v25, v1, 2, 2
  v_lshl_add_u32 v25, v22, 3, v25
  v_bfe_u32 v26, v1, 4, 1
  v_and_b32 v18, 3, v1
  v_lshl_add_u32 v26, v26, 2, v18
  s_cmp_lt_u32 s25, 8
  s_mov_b32 s37, 163840
  s_cselect_b32 s37, 81920, s37
  s_cselect_b32 s40, 1051011932, 1.0
  s_lshr_b32 s46, s36, 3
  s_mul_i32 s46, s46, 20480
  s_add_u32 s49, s46, 5242880
  s_and_b32 s50, s36, 7
  v_and_b32 v18, 0x13, v21
  v_and_b32 v19, 4, v21
  v_lshl_or_b32 v18, v19, 1, v18
  v_and_b32 v19, 8, v21
  v_lshrrev_b32 v19, 1, v19
  v_or_b32 v27, v18, v19
  s_mov_b32 s34, 0
  s_mov_b32 s35, 0
  v_mov_b32 v32, 0
  v_mov_b32 v33, 0
  v_mov_b32 v34, 0
  v_mov_b32 v35, 0
  v_mov_b32 v36, 0
  v_mov_b32 v37, 0
  v_mov_b32 v38, 0
  v_mov_b32 v39, 0
  v_mov_b32 v40, 0
  v_mov_b32 v41, 0
  v_mov_b32 v42, 0
  v_mov_b32 v43, 0
  v_mov_b32 v44, 0
  v_mov_b32 v45, 0
  v_mov_b32 v46, 0
  v_mov_b32 v47, 0
  v_mov_b32 v48, 0
  v_mov_b32 v49, 0
  v_mov_b32 v50, 0
  v_mov_b32 v51, 0
  v_mov_b32 v52, 0
  v_mov_b32 v53, 0
  v_mov_b32 v54, 0
  v_mov_b32 v55, 0
  v_mov_b32 v56, 0
  v_mov_b32 v57, 0
  v_mov_b32 v58, 0
  v_mov_b32 v59, 0
  v_mov_b32 v60, 0
  v_mov_b32 v61, 0
  v_mov_b32 v62, 0
  v_mov_b32 v63, 0
  v_mov_b32 v64, 0
  v_mov_b32 v65, 0
  v_mov_b32 v66, 0
  v_mov_b32 v67, 0
  v_mov_b32 v68, 0
  v_mov_b32 v69, 0
  v_mov_b32 v70, 0
  v_mov_b32 v71, 0
  v_mov_b32 v72, 0
  v_mov_b32 v73, 0
  v_mov_b32 v74, 0
  v_mov_b32 v75, 0
  v_mov_b32 v76, 0
  v_mov_b32 v77, 0
  v_mov_b32 v78, 0
  v_mov_b32 v79, 0
  s_cmp_lt_u32 s26, 4
  s_cbranch_scc0 Lproj_g1
  s_cmp_ge_u32 s25, 12
  s_cbranch_scc1 Lproj_V0
  s_branch Lproj_Q0
Lproj_g1:
  s_cmp_ge_u32 s25, 12
  s_cbranch_scc1 Lproj_V1
  s_cmp_eq_u32 s74, 0
  s_cbranch_scc1 Lproj_Q1k
  s_cmp_eq_u32 s74, 1
  s_cbranch_scc1 Lproj_Q1v
  s_cmp_eq_u32 s74, 2
  s_cbranch_scc1 Lproj_Q1g
  s_branch Lproj_Q1
Lproj_Q0:
  v_lshrrev_b32 v18, 2, v26
  v_mul_u32_u24 v18, 20, v18
  v_and_b32 v19, 1, v26
  v_lshl_add_u32 v18, v19, 1, v18
  v_bfe_u32 v19, v26, 1, 1
  v_add3_u32 v18, v18, v19, 0
  v_mul_u32_u24 v12, 320, v25
  v_lshl_add_u32 v12, v18, 3, v12
  v_add_u32 v12, 16384, v12
  v_lshrrev_b32 v18, 2, v26
  v_mul_u32_u24 v18, 20, v18
  v_and_b32 v19, 1, v26
  v_lshl_add_u32 v18, v19, 1, v18
  v_bfe_u32 v19, v26, 1, 1
  v_add3_u32 v18, v18, v19, 5
  v_mul_u32_u24 v13, 320, v25
  v_lshl_add_u32 v13, v18, 3, v13
  v_add_u32 v13, 16384, v13
  v_lshrrev_b32 v18, 2, v26
  v_mul_u32_u24 v18, 20, v18
  v_and_b32 v19, 1, v26
  v_lshl_add_u32 v18, v19, 1, v18
  v_bfe_u32 v19, v26, 1, 1
  v_add3_u32 v18, v18, v19, 10
  v_mul_u32_u24 v14, 320, v25
  v_lshl_add_u32 v14, v18, 3, v14
  v_add_u32 v14, 16384, v14
  v_add_u32 v8, s34, v7
  v_add_u32 v15, s34, v12
  v_add_u32 v16, s34, v13
  v_add_u32 v17, s34, v14
  v_xor_b32 v9, 32, v8
  v_xor_b32 v10, 64, v8
  v_xor_b32 v11, 96, v8
  s_add_u32 s34, s34, 40960
  s_cmp_eq_u32 s34, 163840
  s_cselect_b32 s34, 0, s34
  s_add_u32 m0, s41, s33
  s_nop 0
  buffer_load_dwordx4 v2, s[8:11], s28 offen lds
  s_add_u32 m0, s42, s33
  s_add_u32 s6, s6, 1
  buffer_load_dwordx4 v3, s[8:11], s28 offen lds
  s_cmp_eq_u32 s6, 10
  s_cselect_b32 s46, -1152, s52
  s_cselect_b32 s6, 0, s6
  s_add_u32 s28, s28, s46
  s_add_u32 m0, s43, s33
  s_nop 0
  buffer_load_dwordx4 v4, s[12:15], s29 offen lds
  s_add_u32 m0, s44, s33
  s_nop 0
  buffer_load_dwordx4 v5, s[12:15], s29 offen lds
  s_add_u32 m0, s45, s33
  s_add_u32 s7, s7, 1
  buffer_load_dwordx4 v6, s[12:15], s29 offen lds
  s_cmp_eq_u32 s7, 10
  s_cselect_b32 s46, s51, s31
  s_cselect_b32 s47, s3, s32
  s_cselect_b32 s7, 0, s7
  s_add_u32 s29, s29, s46
  s_add_u32 s33, s33, 40960
  s_cmp_eq_u32 s33, 163840
  s_cselect_b32 s33, 0, s33
  s_add_u32 m0, s41, s33
  s_nop 0
  buffer_load_dwordx4 v2, s[8:11], s28 offen lds
  s_add_u32 m0, s42, s33
  s_add_u32 s6, s6, 1
  buffer_load_dwordx4 v3, s[8:11], s28 offen lds
  s_cmp_eq_u32 s6, 10
  s_cselect_b32 s46, -1152, s52
  s_cselect_b32 s6, 0, s6
  s_add_u32 s28, s28, s46
  s_waitcnt vmcnt(7)
  s_barrier
  ds_read_b128 v[80:83], v8
  ds_read_b64_tr_b16 v[96:97], v15 offset:0
  ds_read_b64_tr_b16 v[98:99], v15 offset:1280
  ds_read_b64_tr_b16 v[100:101], v16 offset:0
  ds_read_b64_tr_b16 v[102:103], v16 offset:1280
  ds_read_b64_tr_b16 v[104:105], v17 offset:0
  ds_read_b64_tr_b16 v[106:107], v17 offset:1280
  ds_read_b128 v[84:87], v9
  ds_read_b64_tr_b16 v[108:109], v15 offset:5120
  ds_read_b64_tr_b16 v[110:111], v15 offset:6400
  ds_read_b64_tr_b16 v[112:113], v16 offset:5120
  ds_read_b64_tr_b16 v[114:115], v16 offset:6400
  ds_read_b64_tr_b16 v[116:117], v17 offset:5120
  ds_read_b64_tr_b16 v[118:119], v17 offset:6400
Lproj_Q0_loop:
  s_waitcnt lgkmcnt(7)
  v_mfma_f32_32x32x16_bf16 v[32:47], v[96:99], v[80:83], v[32:47]
  ds_read_b128 v[88:91], v10
  ds_read_b64_tr_b16 v[120:121], v15 offset:10240
  ds_read_b64_tr_b16 v[122:123], v15 offset:11520
  ds_read_b64_tr_b16 v[124:125], v16 offset:10240
  v_mfma_f32_32x32x16_bf16 v[48:63], v[100:103], v[80:83], v[48:63]
  ds_read_b64_tr_b16 v[126:127], v16 offset:11520
  ds_read_b64_tr_b16 v[128:129], v17 offset:10240
  ds_read_b64_tr_b16 v[130:131], v17 offset:11520
  s_add_u32 m0, s43, s33
  v_mfma_f32_32x32x16_bf16 v[64:79], v[104:107], v[80:83], v[64:79]
  s_nop 0
  buffer_load_dwordx4 v4, s[12:15], s29 offen lds
  s_waitcnt lgkmcnt(7)
  v_mfma_f32_32x32x16_bf16 v[32:47], v[108:111], v[84:87], v[32:47]
  ds_read_b128 v[92:95], v11
  ds_read_b64_tr_b16 v[132:133], v15 offset:15360
  ds_read_b64_tr_b16 v[134:135], v15 offset:16640
  ds_read_b64_tr_b16 v[136:137], v16 offset:15360
  ds_read_b64_tr_b16 v[138:139], v16 offset:16640
  ds_read_b64_tr_b16 v[140:141], v17 offset:15360
  ds_read_b64_tr_b16 v[142:143], v17 offset:16640
  v_mfma_f32_32x32x16_bf16 v[48:63], v[112:115], v[84:87], v[48:63]
  s_add_u32 m0, s44, s33
  s_nop 0
  buffer_load_dwordx4 v5, s[12:15], s29 offen lds
  s_add_u32 m0, s45, s33
  s_add_u32 s7, s7, 1
  buffer_load_dwordx4 v6, s[12:15], s29 offen lds
  s_cmp_eq_u32 s7, 10
  v_mfma_f32_32x32x16_bf16 v[64:79], v[116:119], v[84:87], v[64:79]
  s_cselect_b32 s46, s51, s31
  s_cselect_b32 s47, s3, s32
  s_cselect_b32 s7, 0, s7
  s_add_u32 s29, s29, s46
  s_add_u32 s33, s33, 40960
  s_cmp_eq_u32 s33, 163840
  s_cselect_b32 s33, 0, s33
  s_waitcnt lgkmcnt(7)
  v_mfma_f32_32x32x16_bf16 v[32:47], v[120:123], v[88:91], v[32:47]
  s_cmp_lt_u32 s35, 7
  s_cselect_b32 s10, s10, 0
  s_cselect_b32 s14, s14, 0
  s_cselect_b32 s18, s18, 0
  v_add_u32 v8, s34, v7
  v_add_u32 v15, s34, v12
  v_add_u32 v16, s34, v13
  v_add_u32 v17, s34, v14
  v_xor_b32 v9, 32, v8
  v_xor_b32 v10, 64, v8
  v_xor_b32 v11, 96, v8
  s_add_u32 s34, s34, 40960
  s_cmp_eq_u32 s34, 163840
  s_cselect_b32 s34, 0, s34
  s_waitcnt vmcnt(5) lgkmcnt(0)
  s_barrier
  v_mfma_f32_32x32x16_bf16 v[48:63], v[124:127], v[88:91], v[48:63]
  ds_read_b128 v[80:83], v8
  ds_read_b64_tr_b16 v[96:97], v15 offset:0
  ds_read_b64_tr_b16 v[98:99], v15 offset:1280
  ds_read_b64_tr_b16 v[100:101], v16 offset:0
  ds_read_b64_tr_b16 v[102:103], v16 offset:1280
  v_mfma_f32_32x32x16_bf16 v[64:79], v[128:131], v[88:91], v[64:79]
  ds_read_b64_tr_b16 v[104:105], v17 offset:0
  ds_read_b64_tr_b16 v[106:107], v17 offset:1280
  s_add_u32 m0, s41, s33
  s_nop 0
  buffer_load_dwordx4 v2, s[8:11], s28 offen lds
  v_mfma_f32_32x32x16_bf16 v[32:47], v[132:135], v[92:95], v[32:47]
  ds_read_b128 v[84:87], v9
  ds_read_b64_tr_b16 v[108:109], v15 offset:5120
  ds_read_b64_tr_b16 v[110:111], v15 offset:6400
  ds_read_b64_tr_b16 v[112:113], v16 offset:5120
  ds_read_b64_tr_b16 v[114:115], v16 offset:6400
  v_mfma_f32_32x32x16_bf16 v[48:63], v[136:139], v[92:95], v[48:63]
  ds_read_b64_tr_b16 v[116:117], v17 offset:5120
  ds_read_b64_tr_b16 v[118:119], v17 offset:6400
  s_add_u32 m0, s42, s33
  s_add_u32 s6, s6, 1
  buffer_load_dwordx4 v3, s[8:11], s28 offen lds
  v_mfma_f32_32x32x16_bf16 v[64:79], v[140:143], v[92:95], v[64:79]
  s_cmp_eq_u32 s6, 10
  s_cselect_b32 s46, -1152, s52
  s_cselect_b32 s6, 0, s6
  s_add_u32 s28, s28, s46
  s_add_u32 s35, s35, 1
  s_cmp_lt_u32 s35, 10
  s_cbranch_scc1 Lproj_Q0_loop
  s_nop 7
  s_waitcnt lgkmcnt(0)
  s_cmp_lt_u32 s25, 8
  s_cselect_b64 vcc, -1, 0
  v_cndmask_b32 v18, v27, v21, vcc
  v_lshlrev_b32 v23, 9, v22
  v_lshl_add_u32 v23, v18, 4, v23
  v_mul_lo_u32 v24, v22, s37
  v_lshl_add_u32 v24, v18, 3, v24
  s_mul_i32 s46, s25, 655360
  s_lshl_b32 s47, s36, 10
  s_add_u32 s38, s46, s47
  s_lshl_b32 s47, s36, 8
  s_add_u32 s39, s46, s47
  s_add_u32 s39, s39, 65536
  s_cmp_lt_u32 s25, 8
  s_cbranch_scc1 Lproj_Q0_isq
  s_sub_u32 s46, s25, 8
  s_mul_i32 s46, s46, 1310720
  s_add_u32 s46, s46, s49
  s_lshl_b32 s47, s50, 10
  s_add_u32 s38, s46, s47
  s_lshl_b32 s47, s50, 8
  s_add_u32 s39, s46, s47
  s_add_u32 s39, s39, 8192
Lproj_Q0_isq:
  v_mov_b32 v20, s40
  s_nop 4
  v_mul_f32 v32, v32, v20
  v_mul_f32 v33, v33, v20
  v_mul_f32 v34, v34, v20
  v_mul_f32 v35, v35, v20
  v_mul_f32 v36, v36, v20
  v_mul_f32 v37, v37, v20
  v_mul_f32 v38, v38, v20
  v_mul_f32 v39, v39, v20
  v_mul_f32 v40, v40, v20
  v_mul_f32 v41, v41, v20
  v_mul_f32 v42, v42, v20
  v_mul_f32 v43, v43, v20
  v_mul_f32 v44, v44, v20
  v_mul_f32 v45, v45, v20
  v_mul_f32 v46, v46, v20
  v_mul_f32 v47, v47, v20
  v_cvt_pk_bf16_f32 v80, v32, v33
  v_cvt_pk_bf16_f32 v81, v34, v35
  v_cvt_pk_bf16_f32 v82, v36, v37
  v_cvt_pk_bf16_f32 v83, v38, v39
  v_cvt_pk_bf16_f32 v84, v40, v41
  v_cvt_pk_bf16_f32 v85, v42, v43
  v_cvt_pk_bf16_f32 v86, v44, v45
  v_cvt_pk_bf16_f32 v87, v46, v47
  s_mul_i32 s46, s37, 0
  s_add_u32 s46, s46, s38
  buffer_store_dwordx4 v[80:83], v23, s[20:23], s46 offen sc0 sc1
  s_mul_i32 s46, s37, 4
  s_add_u32 s46, s46, s38
  buffer_store_dwordx4 v[84:87], v23, s[20:23], s46 offen sc0 sc1
  v_mul_f32 v48, v48, v20
  v_mul_f32 v49, v49, v20
  v_mul_f32 v50, v50, v20
  v_mul_f32 v51, v51, v20
  v_mul_f32 v52, v52, v20
  v_mul_f32 v53, v53, v20
  v_mul_f32 v54, v54, v20
  v_mul_f32 v55, v55, v20
  v_mul_f32 v56, v56, v20
  v_mul_f32 v57, v57, v20
  v_mul_f32 v58, v58, v20
  v_mul_f32 v59, v59, v20
  v_mul_f32 v60, v60, v20
  v_mul_f32 v61, v61, v20
  v_mul_f32 v62, v62, v20
  v_mul_f32 v63, v63, v20
  v_cvt_pk_bf16_f32 v88, v48, v49
  v_cvt_pk_bf16_f32 v89, v50, v51
  v_cvt_pk_bf16_f32 v90, v52, v53
  v_cvt_pk_bf16_f32 v91, v54, v55
  v_cvt_pk_bf16_f32 v92, v56, v57
  v_cvt_pk_bf16_f32 v93, v58, v59
  v_cvt_pk_bf16_f32 v94, v60, v61
  v_cvt_pk_bf16_f32 v95, v62, v63
  s_mul_i32 s46, s37, 1
  s_add_u32 s46, s46, s38
  buffer_store_dwordx4 v[88:91], v23, s[20:23], s46 offen sc0 sc1
  s_mul_i32 s46, s37, 5
  s_add_u32 s46, s46, s38
  buffer_store_dwordx4 v[92:95], v23, s[20:23], s46 offen sc0 sc1
  v_mul_f32 v64, v64, v20
  v_mul_f32 v65, v65, v20
  v_mul_f32 v66, v66, v20
  v_mul_f32 v67, v67, v20
  v_mul_f32 v68, v68, v20
  v_mul_f32 v69, v69, v20
  v_mul_f32 v70, v70, v20
  v_mul_f32 v71, v71, v20
  v_mul_f32 v72, v72, v20
  v_mul_f32 v73, v73, v20
  v_mul_f32 v74, v74, v20
  v_mul_f32 v75, v75, v20
  v_mul_f32 v76, v76, v20
  v_mul_f32 v77, v77, v20
  v_mul_f32 v78, v78, v20
  v_mul_f32 v79, v79, v20
  v_cvt_pk_bf16_f32 v96, v64, v65
  v_cvt_pk_bf16_f32 v97, v66, v67
  v_cvt_pk_bf16_f32 v98, v68, v69
  v_cvt_pk_bf16_f32 v99, v70, v71
  v_cvt_pk_bf16_f32 v100, v72, v73
  v_cvt_pk_bf16_f32 v101, v74, v75
  v_cvt_pk_bf16_f32 v102, v76, v77
  v_cvt_pk_bf16_f32 v103, v78, v79
  s_mul_i32 s46, s37, 2
  s_add_u32 s46, s46, s38
  buffer_store_dwordx4 v[96:99], v23, s[20:23], s46 offen sc0 sc1
  s_mul_i32 s46, s37, 6
  s_add_u32 s46, s46, s38
  buffer_store_dwordx4 v[100:103], v23, s[20:23], s46 offen sc0 sc1
  s_endpgm
Lproj_V0:
  v_add_u32 v18, 0, v26
  v_mul_u32_u24 v12, 320, v25
  v_lshl_add_u32 v12, v18, 3, v12
  v_add_u32 v12, 16384, v12
  v_add_u32 v18, 8, v26
  v_mul_u32_u24 v13, 320, v25
  v_lshl_add_u32 v13, v18, 3, v13
  v_add_u32 v13, 16384, v13
  v_add_u32 v18, 16, v26
  v_mul_u32_u24 v14, 320, v25
  v_lshl_add_u32 v14, v18, 3, v14
  v_add_u32 v14, 16384, v14
  v_add_u32 v8, s34, v7
  v_add_u32 v15, s34, v12
  v_add_u32 v16, s34, v13
  v_add_u32 v17, s34, v14
  v_xor_b32 v9, 32, v8
  v_xor_b32 v10, 64, v8
  v_xor_b32 v11, 96, v8
  s_add_u32 s34, s34, 40960
  s_cmp_eq_u32 s34, 163840
  s_cselect_b32 s34, 0, s34
  s_add_u32 m0, s41, s33
  s_nop 0
  buffer_load_dwordx4 v2, s[8:11], s28 offen lds
  s_add_u32 m0, s42, s33
  s_add_u32 s6, s6, 1
  buffer_load_dwordx4 v3, s[8:11], s28 offen lds
  s_cmp_eq_u32 s6, 10
  s_cselect_b32 s46, -1152, s52
  s_cselect_b32 s6, 0, s6
  s_add_u32 s28, s28, s46
  s_add_u32 m0, s43, s33
  s_nop 0
  buffer_load_dwordx4 v4, s[12:15], s29 offen lds
  s_add_u32 m0, s44, s33
  s_nop 0
  buffer_load_dwordx4 v5, s[12:15], s29 offen lds
  s_add_u32 m0, s45, s33
  s_add_u32 s7, s7, 1
  buffer_load_dwordx4 v6, s[12:15], s29 offen lds
  s_cmp_eq_u32 s7, 10
  s_cselect_b32 s46, s51, s31
  s_cselect_b32 s47, s3, s32
  s_cselect_b32 s7, 0, s7
  s_add_u32 s29, s29, s46
  s_add_u32 s33, s33, 40960
  s_cmp_eq_u32 s33, 163840
  s_cselect_b32 s33, 0, s33
  s_add_u32 m0, s41, s33
  s_nop 0
  buffer_load_dwordx4 v2, s[8:11], s28 offen lds
  s_add_u32 m0, s42, s33
  s_add_u32 s6, s6, 1
  buffer_load_dwordx4 v3, s[8:11], s28 offen lds
  s_cmp_eq_u32 s6, 10
  s_cselect_b32 s46, -1152, s52
  s_cselect_b32 s6, 0, s6
  s_add_u32 s28, s28, s46
  s_waitcnt vmcnt(7)
  s_barrier
  ds_read_b128 v[80:83], v8
  ds_read_b64_tr_b16 v[96:97], v15 offset:0
  ds_read_b64_tr_b16 v[98:99], v15 offset:1280
  ds_read_b64_tr_b16 v[100:101], v16 offset:0
  ds_read_b64_tr_b16 v[102:103], v16 offset:1280
  ds_read_b64_tr_b16 v[104:105], v17 offset:0
  ds_read_b64_tr_b16 v[106:107], v17 offset:1280
  ds_read_b128 v[84:87], v9
  ds_read_b64_tr_b16 v[108:109], v15 offset:5120
  ds_read_b64_tr_b16 v[110:111], v15 offset:6400
  ds_read_b64_tr_b16 v[112:113], v16 offset:5120
  ds_read_b64_tr_b16 v[114:115], v16 offset:6400
  ds_read_b64_tr_b16 v[116:117], v17 offset:5120
  ds_read_b64_tr_b16 v[118:119], v17 offset:6400
Lproj_V0_loop:
  s_waitcnt lgkmcnt(7)
  v_mfma_f32_32x32x16_bf16 v[32:47], v[80:83], v[96:99], v[32:47]
  ds_read_b128 v[88:91], v10
  ds_read_b64_tr_b16 v[120:121], v15 offset:10240
  ds_read_b64_tr_b16 v[122:123], v15 offset:11520
  ds_read_b64_tr_b16 v[124:125], v16 offset:10240
  v_mfma_f32_32x32x16_bf16 v[48:63], v[80:83], v[100:103], v[48:63]
  ds_read_b64_tr_b16 v[126:127], v16 offset:11520
  ds_read_b64_tr_b16 v[128:129], v17 offset:10240
  ds_read_b64_tr_b16 v[130:131], v17 offset:11520
  s_add_u32 m0, s43, s33
  v_mfma_f32_32x32x16_bf16 v[64:79], v[80:83], v[104:107], v[64:79]
  s_nop 0
  buffer_load_dwordx4 v4, s[12:15], s29 offen lds
  s_waitcnt lgkmcnt(7)
  v_mfma_f32_32x32x16_bf16 v[32:47], v[84:87], v[108:111], v[32:47]
  ds_read_b128 v[92:95], v11
  ds_read_b64_tr_b16 v[132:133], v15 offset:15360
  ds_read_b64_tr_b16 v[134:135], v15 offset:16640
  ds_read_b64_tr_b16 v[136:137], v16 offset:15360
  ds_read_b64_tr_b16 v[138:139], v16 offset:16640
  ds_read_b64_tr_b16 v[140:141], v17 offset:15360
  ds_read_b64_tr_b16 v[142:143], v17 offset:16640
  v_mfma_f32_32x32x16_bf16 v[48:63], v[84:87], v[112:115], v[48:63]
  s_add_u32 m0, s44, s33
  s_nop 0
  buffer_load_dwordx4 v5, s[12:15], s29 offen lds
  s_add_u32 m0, s45, s33
  s_add_u32 s7, s7, 1
  buffer_load_dwordx4 v6, s[12:15], s29 offen lds
  s_cmp_eq_u32 s7, 10
  v_mfma_f32_32x32x16_bf16 v[64:79], v[84:87], v[116:119], v[64:79]
  s_cselect_b32 s46, s51, s31
  s_cselect_b32 s47, s3, s32
  s_cselect_b32 s7, 0, s7
  s_add_u32 s29, s29, s46
  s_add_u32 s33, s33, 40960
  s_cmp_eq_u32 s33, 163840
  s_cselect_b32 s33, 0, s33
  s_waitcnt lgkmcnt(7)
  v_mfma_f32_32x32x16_bf16 v[32:47], v[88:91], v[120:123], v[32:47]
  s_cmp_lt_u32 s35, 7
  s_cselect_b32 s10, s10, 0
  s_cselect_b32 s14, s14, 0
  s_cselect_b32 s18, s18, 0
  v_add_u32 v8, s34, v7
  v_add_u32 v15, s34, v12
  v_add_u32 v16, s34, v13
  v_add_u32 v17, s34, v14
  v_xor_b32 v9, 32, v8
  v_xor_b32 v10, 64, v8
  v_xor_b32 v11, 96, v8
  s_add_u32 s34, s34, 40960
  s_cmp_eq_u32 s34, 163840
  s_cselect_b32 s34, 0, s34
  s_waitcnt vmcnt(5) lgkmcnt(0)
  s_barrier
  v_mfma_f32_32x32x16_bf16 v[48:63], v[88:91], v[124:127], v[48:63]
  ds_read_b128 v[80:83], v8
  ds_read_b64_tr_b16 v[96:97], v15 offset:0
  ds_read_b64_tr_b16 v[98:99], v15 offset:1280
  ds_read_b64_tr_b16 v[100:101], v16 offset:0
  ds_read_b64_tr_b16 v[102:103], v16 offset:1280
  v_mfma_f32_32x32x16_bf16 v[64:79], v[88:91], v[128:131], v[64:79]
  ds_read_b64_tr_b16 v[104:105], v17 offset:0
  ds_read_b64_tr_b16 v[106:107], v17 offset:1280
  s_add_u32 m0, s41, s33
  s_nop 0
  buffer_load_dwordx4 v2, s[8:11], s28 offen lds
  v_mfma_f32_32x32x16_bf16 v[32:47], v[92:95], v[132:135], v[32:47]
  ds_read_b128 v[84:87], v9
  ds_read_b64_tr_b16 v[108:109], v15 offset:5120
  ds_read_b64_tr_b16 v[110:111], v15 offset:6400
  ds_read_b64_tr_b16 v[112:113], v16 offset:5120
  ds_read_b64_tr_b16 v[114:115], v16 offset:6400
  v_mfma_f32_32x32x16_bf16 v[48:63], v[92:95], v[136:139], v[48:63]
  ds_read_b64_tr_b16 v[116:117], v17 offset:5120
  ds_read_b64_tr_b16 v[118:119], v17 offset:6400
  s_add_u32 m0, s42, s33
  s_add_u32 s6, s6, 1
  buffer_load_dwordx4 v3, s[8:11], s28 offen lds
  v_mfma_f32_32x32x16_bf16 v[64:79], v[92:95], v[140:143], v[64:79]
  s_cmp_eq_u32 s6, 10
  s_cselect_b32 s46, -1152, s52
  s_cselect_b32 s6, 0, s6
  s_add_u32 s28, s28, s46
  s_add_u32 s35, s35, 1
  s_cmp_lt_u32 s35, 10
  s_cbranch_scc1 Lproj_V0_loop
  s_nop 7
  s_waitcnt lgkmcnt(0)
  s_nop 15
  v_cvt_pk_bf16_f32 v80, v32, v33
  v_cvt_pk_bf16_f32 v81, v34, v35
  v_cvt_pk_bf16_f32 v82, v36, v37
  v_cvt_pk_bf16_f32 v83, v38, v39
  v_cvt_pk_bf16_f32 v84, v40, v41
  v_cvt_pk_bf16_f32 v85, v42, v43
  v_cvt_pk_bf16_f32 v86, v44, v45
  v_cvt_pk_bf16_f32 v87, v46, v47
  v_add_u32 v18, 0, v21
  v_mul_u32_u24 v19, 205, v18
  v_lshrrev_b32 v19, 12, v19
  v_mul_u32_u24 v25, 20, v19
  v_sub_u32 v18, v18, v25
  v_and_b32 v25, 0x13, v18
  v_and_b32 v26, 4, v18
  v_lshl_or_b32 v25, v26, 1, v25
  v_and_b32 v26, 8, v18
  v_lshrrev_b32 v26, 1, v26
  v_or_b32 v25, v25, v26
  v_mul_u32_u24 v26, 320, v22
  v_lshl_add_u32 v25, v25, 4, v26
  s_mov_b32 s46, 163840
  v_mul_lo_u32 v19, v19, s46
  v_add_u32 v25, v25, v19
  s_sub_u32 s46, s25, 12
  s_mul_i32 s46, s46, 1310720
  s_add_u32 s46, s46, s49
  s_mul_i32 s47, s50, 1280
  s_add_u32 s46, s46, s47
  s_add_u32 s46, s46, 10240
  buffer_store_dwordx4 v[80:83], v25, s[20:23], s46 offen sc0 sc1
  buffer_store_dwordx4 v[84:87], v25, s[20:23], s46 offen offset:640 sc0 sc1
  v_cvt_pk_bf16_f32 v88, v48, v49
  v_cvt_pk_bf16_f32 v89, v50, v51
  v_cvt_pk_bf16_f32 v90, v52, v53
  v_cvt_pk_bf16_f32 v91, v54, v55
  v_cvt_pk_bf16_f32 v92, v56, v57
  v_cvt_pk_bf16_f32 v93, v58, v59
  v_cvt_pk_bf16_f32 v94, v60, v61
  v_cvt_pk_bf16_f32 v95, v62, v63
  v_add_u32 v18, 32, v21
  v_mul_u32_u24 v19, 205, v18
  v_lshrrev_b32 v19, 12, v19
  v_mul_u32_u24 v25, 20, v19
  v_sub_u32 v18, v18, v25
  v_and_b32 v25, 0x13, v18
  v_and_b32 v26, 4, v18
  v_lshl_or_b32 v25, v26, 1, v25
  v_and_b32 v26, 8, v18
  v_lshrrev_b32 v26, 1, v26
  v_or_b32 v25, v25, v26
  v_mul_u32_u24 v26, 320, v22
  v_lshl_add_u32 v25, v25, 4, v26
  s_mov_b32 s46, 163840
  v_mul_lo_u32 v19, v19, s46
  v_add_u32 v25, v25, v19
  s_sub_u32 s46, s25, 12
  s_mul_i32 s46, s46, 1310720
  s_add_u32 s46, s46, s49
  s_mul_i32 s47, s50, 1280
  s_add_u32 s46, s46, s47
  s_add_u32 s46, s46, 10240
  buffer_store_dwordx4 v[88:91], v25, s[20:23], s46 offen sc0 sc1
  buffer_store_dwordx4 v[92:95], v25, s[20:23], s46 offen offset:640 sc0 sc1
  v_cvt_pk_bf16_f32 v96, v64, v65
  v_cvt_pk_bf16_f32 v97, v66, v67
  v_cvt_pk_bf16_f32 v98, v68, v69
  v_cvt_pk_bf16_f32 v99, v70, v71
  v_cvt_pk_bf16_f32 v100, v72, v73
  v_cvt_pk_bf16_f32 v101, v74, v75
  v_cvt_pk_bf16_f32 v102, v76, v77
  v_cvt_pk_bf16_f32 v103, v78, v79
  v_add_u32 v18, 64, v21
  v_mul_u32_u24 v19, 205, v18
  v_lshrrev_b32 v19, 12, v19
  v_mul_u32_u24 v25, 20, v19
  v_sub_u32 v18, v18, v25
  v_and_b32 v25, 0x13, v18
  v_and_b32 v26, 4, v18
  v_lshl_or_b32 v25, v26, 1, v25
  v_and_b32 v26, 8, v18
  v_lshrrev_b32 v26, 1, v26
  v_or_b32 v25, v25, v26
  v_mul_u32_u24 v26, 320, v22
  v_lshl_add_u32 v25, v25, 4, v26
  s_mov_b32 s46, 163840
  v_mul_lo_u32 v19, v19, s46
  v_add_u32 v25, v25, v19
  s_sub_u32 s46, s25, 12
  s_mul_i32 s46, s46, 1310720
  s_add_u32 s46, s46, s49
  s_mul_i32 s47, s50, 1280
  s_add_u32 s46, s46, s47
  s_add_u32 s46, s46, 10240
  buffer_store_dwordx4 v[96:99], v25, s[20:23], s46 offen sc0 sc1
  buffer_store_dwordx4 v[100:103], v25, s[20:23], s46 offen offset:640 sc0 sc1
  s_endpgm
Lproj_Q1:
  v_lshrrev_b32 v18, 2, v26
  v_mul_u32_u24 v18, 20, v18
  v_and_b32 v19, 1, v26
  v_lshl_add_u32 v18, v19, 1, v18
  v_bfe_u32 v19, v26, 1, 1
  v_add3_u32 v18, v18, v19, 15
  v_mul_u32_u24 v12, 320, v25
  v_lshl_add_u32 v12, v18, 3, v12
  v_add_u32 v12, 16384, v12
  v_mul_u32_u24 v18, 5, v26
  v_add_u32 v18, 4, v18
  v_mul_u32_u24 v13, 320, v25
  v_lshl_add_u32 v13, v18, 3, v13
  v_add_u32 v13, 16384, v13
  v_add_u32 v8, s34, v7
  v_add_u32 v15, s34, v12
  v_add_u32 v16, s34, v13
  v_xor_b32 v9, 32, v8
  v_xor_b32 v10, 64, v8
  v_xor_b32 v11, 96, v8
  s_add_u32 s34, s34, 40960
  s_cmp_eq_u32 s34, 163840
  s_cselect_b32 s34, 0, s34
  s_add_u32 m0, s41, s33
  s_nop 0
  buffer_load_dwordx4 v2, s[8:11], s28 offen lds
  s_add_u32 m0, s42, s33
  s_add_u32 s6, s6, 1
  buffer_load_dwordx4 v3, s[8:11], s28 offen lds
  s_cmp_eq_u32 s6, 10
  s_cselect_b32 s46, -1152, s52
  s_cselect_b32 s6, 0, s6
  s_add_u32 s28, s28, s46
  s_add_u32 m0, s43, s33
  s_nop 0
  buffer_load_dwordx4 v4, s[12:15], s29 offen lds
  s_add_u32 m0, s44, s33
  s_nop 0
  buffer_load_dwordx4 v5, s[12:15], s29 offen lds
  s_add_u32 m0, s45, s33
  s_add_u32 s7, s7, 1
  buffer_load_dwordx4 v6, s[16:19], s30 offen lds
  s_cmp_eq_u32 s7, 10
  s_cselect_b32 s46, s51, s31
  s_cselect_b32 s47, s3, s32
  s_cselect_b32 s7, 0, s7
  s_add_u32 s29, s29, s46
  s_add_u32 s30, s30, s47
  s_add_u32 s33, s33, 40960
  s_cmp_eq_u32 s33, 163840
  s_cselect_b32 s33, 0, s33
  s_add_u32 m0, s41, s33
  s_nop 0
  buffer_load_dwordx4 v2, s[8:11], s28 offen lds
  s_add_u32 m0, s42, s33
  s_add_u32 s6, s6, 1
  buffer_load_dwordx4 v3, s[8:11], s28 offen lds
  s_cmp_eq_u32 s6, 10
  s_cselect_b32 s46, -1152, s52
  s_cselect_b32 s6, 0, s6
  s_add_u32 s28, s28, s46
  s_waitcnt vmcnt(7)
  s_barrier
  ds_read_b128 v[80:83], v8
  ds_read_b64_tr_b16 v[96:97], v15 offset:0
  ds_read_b64_tr_b16 v[98:99], v15 offset:1280
  ds_read_b64_tr_b16 v[100:101], v16 offset:0
  ds_read_b64_tr_b16 v[102:103], v16 offset:1280
  ds_read_b128 v[84:87], v9
  ds_read_b64_tr_b16 v[108:109], v15 offset:5120
  ds_read_b64_tr_b16 v[110:111], v15 offset:6400
  ds_read_b64_tr_b16 v[112:113], v16 offset:5120
  ds_read_b64_tr_b16 v[114:115], v16 offset:6400
Lproj_Q1_loop:
  s_waitcnt lgkmcnt(5)
  v_mfma_f32_32x32x16_bf16 v[32:47], v[96:99], v[80:83], v[32:47]
  ds_read_b128 v[88:91], v10
  ds_read_b64_tr_b16 v[120:121], v15 offset:10240
  ds_read_b64_tr_b16 v[122:123], v15 offset:11520
  ds_read_b64_tr_b16 v[124:125], v16 offset:10240
  v_mfma_f32_32x32x16_bf16 v[48:63], v[100:103], v[80:83], v[48:63]
  ds_read_b64_tr_b16 v[126:127], v16 offset:11520
  s_add_u32 m0, s43, s33
  s_nop 0
  buffer_load_dwordx4 v4, s[12:15], s29 offen lds
  s_waitcnt lgkmcnt(5)
  v_mfma_f32_32x32x16_bf16 v[32:47], v[108:111], v[84:87], v[32:47]
  ds_read_b128 v[92:95], v11
  ds_read_b64_tr_b16 v[132:133], v15 offset:15360
  ds_read_b64_tr_b16 v[134:135], v15 offset:16640
  ds_read_b64_tr_b16 v[136:137], v16 offset:15360
  ds_read_b64_tr_b16 v[138:139], v16 offset:16640
  s_add_u32 m0, s44, s33
  s_nop 0
  buffer_load_dwordx4 v5, s[12:15], s29 offen lds
  s_add_u32 m0, s45, s33
  s_add_u32 s7, s7, 1
  v_mfma_f32_32x32x16_bf16 v[48:63], v[112:115], v[84:87], v[48:63]
  buffer_load_dwordx4 v6, s[16:19], s30 offen lds
  s_cmp_eq_u32 s7, 10
  s_cselect_b32 s46, s51, s31
  s_cselect_b32 s47, s3, s32
  s_cselect_b32 s7, 0, s7
  s_add_u32 s29, s29, s46
  s_add_u32 s30, s30, s47
  s_add_u32 s33, s33, 40960
  s_cmp_eq_u32 s33, 163840
  s_cselect_b32 s33, 0, s33
  s_waitcnt lgkmcnt(5)
  v_mfma_f32_32x32x16_bf16 v[32:47], v[120:123], v[88:91], v[32:47]
  s_cmp_lt_u32 s35, 7
  s_cselect_b32 s10, s10, 0
  s_cselect_b32 s14, s14, 0
  s_cselect_b32 s18, s18, 0
  v_add_u32 v8, s34, v7
  v_add_u32 v15, s34, v12
  v_add_u32 v16, s34, v13
  v_xor_b32 v9, 32, v8
  v_xor_b32 v10, 64, v8
  v_xor_b32 v11, 96, v8
  s_add_u32 s34, s34, 40960
  s_cmp_eq_u32 s34, 163840
  s_cselect_b32 s34, 0, s34
  s_waitcnt vmcnt(5) lgkmcnt(0)
  s_barrier
  v_mfma_f32_32x32x16_bf16 v[48:63], v[124:127], v[88:91], v[48:63]
  ds_read_b128 v[80:83], v8
  ds_read_b64_tr_b16 v[96:97], v15 offset:0
  ds_read_b64_tr_b16 v[98:99], v15 offset:1280
  ds_read_b64_tr_b16 v[100:101], v16 offset:0
  ds_read_b64_tr_b16 v[102:103], v16 offset:1280
  s_add_u32 m0, s41, s33
  s_nop 0
  buffer_load_dwordx4 v2, s[8:11], s28 offen lds
  v_mfma_f32_32x32x16_bf16 v[32:47], v[132:135], v[92:95], v[32:47]
  ds_read_b128 v[84:87], v9
  ds_read_b64_tr_b16 v[108:109], v15 offset:5120
  ds_read_b64_tr_b16 v[110:111], v15 offset:6400
  ds_read_b64_tr_b16 v[112:113], v16 offset:5120
  ds_read_b64_tr_b16 v[114:115], v16 offset:6400
  s_add_u32 m0, s42, s33
  v_mfma_f32_32x32x16_bf16 v[48:63], v[136:139], v[92:95], v[48:63]
  s_add_u32 s6, s6, 1
  buffer_load_dwordx4 v3, s[8:11], s28 offen lds
  s_cmp_eq_u32 s6, 10
  s_cselect_b32 s46, -1152, s52
  s_cselect_b32 s6, 0, s6
  s_add_u32 s28, s28, s46
  s_add_u32 s35, s35, 1
  s_cmp_lt_u32 s35, 10
  s_cbranch_scc1 Lproj_Q1_loop
  s_nop 7
  s_waitcnt lgkmcnt(0)
  s_cmp_lt_u32 s25, 8
  s_cselect_b64 vcc, -1, 0
  v_cndmask_b32 v18, v27, v21, vcc
  v_lshlrev_b32 v23, 9, v22
  v_lshl_add_u32 v23, v18, 4, v23
  v_mul_lo_u32 v24, v22, s37
  v_lshl_add_u32 v24, v18, 3, v24
  s_mul_i32 s46, s25, 655360
  s_lshl_b32 s47, s36, 10
  s_add_u32 s38, s46, s47
  s_lshl_b32 s47, s36, 8
  s_add_u32 s39, s46, s47
  s_add_u32 s39, s39, 65536
  s_cmp_lt_u32 s25, 8
  s_cbranch_scc1 Lproj_Q1_isq
  s_sub_u32 s46, s25, 8
  s_mul_i32 s46, s46, 1310720
  s_add_u32 s46, s46, s49
  s_lshl_b32 s47, s50, 10
  s_add_u32 s38, s46, s47
  s_lshl_b32 s47, s50, 8
  s_add_u32 s39, s46, s47
  s_add_u32 s39, s39, 8192
Lproj_Q1_isq:
  v_mov_b32 v20, s40
  s_nop 4
  v_mul_f32 v32, v32, v20
  v_mul_f32 v33, v33, v20
  v_mul_f32 v34, v34, v20
  v_mul_f32 v35, v35, v20
  v_mul_f32 v36, v36, v20
  v_mul_f32 v37, v37, v20
  v_mul_f32 v38, v38, v20
  v_mul_f32 v39, v39, v20
  v_mul_f32 v40, v40, v20
  v_mul_f32 v41, v41, v20
  v_mul_f32 v42, v42, v20
  v_mul_f32 v43, v43, v20
  v_mul_f32 v44, v44, v20
  v_mul_f32 v45, v45, v20
  v_mul_f32 v46, v46, v20
  v_mul_f32 v47, v47, v20
  v_cvt_pk_bf16_f32 v80, v32, v33
  v_cvt_pk_bf16_f32 v81, v34, v35
  v_cvt_pk_bf16_f32 v82, v36, v37
  v_cvt_pk_bf16_f32 v83, v38, v39
  v_cvt_pk_bf16_f32 v84, v40, v41
  v_cvt_pk_bf16_f32 v85, v42, v43
  v_cvt_pk_bf16_f32 v86, v44, v45
  v_cvt_pk_bf16_f32 v87, v46, v47
  s_mul_i32 s46, s37, 3
  s_add_u32 s46, s46, s38
  buffer_store_dwordx4 v[80:83], v23, s[20:23], s46 offen sc0 sc1
  s_mul_i32 s46, s37, 7
  s_add_u32 s46, s46, s38
  buffer_store_dwordx4 v[84:87], v23, s[20:23], s46 offen sc0 sc1
  v_mul_f32 v48, v48, v20
  v_mul_f32 v49, v49, v20
  v_mul_f32 v50, v50, v20
  v_mul_f32 v51, v51, v20
  v_mul_f32 v52, v52, v20
  v_mul_f32 v53, v53, v20
  v_mul_f32 v54, v54, v20
  v_mul_f32 v55, v55, v20
  v_mul_f32 v56, v56, v20
  v_mul_f32 v57, v57, v20
  v_mul_f32 v58, v58, v20
  v_mul_f32 v59, v59, v20
  v_mul_f32 v60, v60, v20
  v_mul_f32 v61, v61, v20
  v_mul_f32 v62, v62, v20
  v_mul_f32 v63, v63, v20
  v_cvt_pk_bf16_f32 v88, v48, v49
  v_cvt_pk_bf16_f32 v89, v50, v51
  v_cvt_pk_bf16_f32 v90, v52, v53
  v_cvt_pk_bf16_f32 v91, v54, v55
  v_cvt_pk_bf16_f32 v92, v56, v57
  v_cvt_pk_bf16_f32 v93, v58, v59
  v_cvt_pk_bf16_f32 v94, v60, v61
  v_cvt_pk_bf16_f32 v95, v62, v63
  s_mul_i32 s46, s37, 0
  s_add_u32 s46, s46, s39
  buffer_store_dwordx2 v[88:89], v24, s[20:23], s46 offen sc0 sc1
  s_mul_i32 s46, s37, 2
  s_add_u32 s46, s46, s39
  buffer_store_dwordx2 v[90:91], v24, s[20:23], s46 offen sc0 sc1
  s_mul_i32 s46, s37, 4
  s_add_u32 s46, s46, s39
  buffer_store_dwordx2 v[92:93], v24, s[20:23], s46 offen sc0 sc1
  s_mul_i32 s46, s37, 6
  s_add_u32 s46, s46, s39
  buffer_store_dwordx2 v[94:95], v24, s[20:23], s46 offen sc0 sc1
  s_endpgm
Lproj_V1:
  v_add_u32 v18, 24, v26
  v_mul_u32_u24 v12, 320, v25
  v_lshl_add_u32 v12, v18, 3, v12
  v_add_u32 v12, 16384, v12
  v_add_u32 v18, 32, v26
  v_mul_u32_u24 v13, 320, v25
  v_lshl_add_u32 v13, v18, 3, v13
  v_add_u32 v13, 16384, v13
  v_add_u32 v8, s34, v7
  v_add_u32 v15, s34, v12
  v_add_u32 v16, s34, v13
  v_xor_b32 v9, 32, v8
  v_xor_b32 v10, 64, v8
  v_xor_b32 v11, 96, v8
  s_add_u32 s34, s34, 40960
  s_cmp_eq_u32 s34, 163840
  s_cselect_b32 s34, 0, s34
  s_add_u32 m0, s41, s33
  s_nop 0
  buffer_load_dwordx4 v2, s[8:11], s28 offen lds
  s_add_u32 m0, s42, s33
  s_add_u32 s6, s6, 1
  buffer_load_dwordx4 v3, s[8:11], s28 offen lds
  s_cmp_eq_u32 s6, 10
  s_cselect_b32 s46, -1152, s52
  s_cselect_b32 s6, 0, s6
  s_add_u32 s28, s28, s46
  s_add_u32 m0, s43, s33
  s_nop 0
  buffer_load_dwordx4 v4, s[12:15], s29 offen lds
  s_add_u32 m0, s44, s33
  s_nop 0
  buffer_load_dwordx4 v5, s[12:15], s29 offen lds
  s_add_u32 m0, s45, s33
  s_add_u32 s7, s7, 1
  buffer_load_dwordx4 v6, s[16:19], s30 offen lds
  s_cmp_eq_u32 s7, 10
  s_cselect_b32 s46, s51, s31
  s_cselect_b32 s47, s3, s32
  s_cselect_b32 s7, 0, s7
  s_add_u32 s29, s29, s46
  s_add_u32 s30, s30, s47
  s_add_u32 s33, s33, 40960
  s_cmp_eq_u32 s33, 163840
  s_cselect_b32 s33, 0, s33
  s_add_u32 m0, s41, s33
  s_nop 0
  buffer_load_dwordx4 v2, s[8:11], s28 offen lds
  s_add_u32 m0, s42, s33
  s_add_u32 s6, s6, 1
  buffer_load_dwordx4 v3, s[8:11], s28 offen lds
  s_cmp_eq_u32 s6, 10
  s_cselect_b32 s46, -1152, s52
  s_cselect_b32 s6, 0, s6
  s_add_u32 s28, s28, s46
  s_waitcnt vmcnt(7)
  s_barrier
  ds_read_b128 v[80:83], v8
  ds_read_b64_tr_b16 v[96:97], v15 offset:0
  ds_read_b64_tr_b16 v[98:99], v15 offset:1280
  ds_read_b64_tr_b16 v[100:101], v16 offset:0
  ds_read_b64_tr_b16 v[102:103], v16 offset:1280
  ds_read_b128 v[84:87], v9
  ds_read_b64_tr_b16 v[108:109], v15 offset:5120
  ds_read_b64_tr_b16 v[110:111], v15 offset:6400
  ds_read_b64_tr_b16 v[112:113], v16 offset:5120
  ds_read_b64_tr_b16 v[114:115], v16 offset:6400
Lproj_V1_loop:
  s_waitcnt lgkmcnt(5)
  v_mfma_f32_32x32x16_bf16 v[32:47], v[80:83], v[96:99], v[32:47]
  ds_read_b128 v[88:91], v10
  ds_read_b64_tr_b16 v[120:121], v15 offset:10240
  ds_read_b64_tr_b16 v[122:123], v15 offset:11520
  ds_read_b64_tr_b16 v[124:125], v16 offset:10240
  v_mfma_f32_32x32x16_bf16 v[48:63], v[80:83], v[100:103], v[48:63]
  ds_read_b64_tr_b16 v[126:127], v16 offset:11520
  s_add_u32 m0, s43, s33
  s_nop 0
  buffer_load_dwordx4 v4, s[12:15], s29 offen lds
  s_waitcnt lgkmcnt(5)
  v_mfma_f32_32x32x16_bf16 v[32:47], v[84:87], v[108:111], v[32:47]
  ds_read_b128 v[92:95], v11
  ds_read_b64_tr_b16 v[132:133], v15 offset:15360
  ds_read_b64_tr_b16 v[134:135], v15 offset:16640
  ds_read_b64_tr_b16 v[136:137], v16 offset:15360
  ds_read_b64_tr_b16 v[138:139], v16 offset:16640
  s_add_u32 m0, s44, s33
  s_nop 0
  buffer_load_dwordx4 v5, s[12:15], s29 offen lds
  s_add_u32 m0, s45, s33
  s_add_u32 s7, s7, 1
  v_mfma_f32_32x32x16_bf16 v[48:63], v[84:87], v[112:115], v[48:63]
  buffer_load_dwordx4 v6, s[16:19], s30 offen lds
  s_cmp_eq_u32 s7, 10
  s_cselect_b32 s46, s51, s31
  s_cselect_b32 s47, s3, s32
  s_cselect_b32 s7, 0, s7
  s_add_u32 s29, s29, s46
  s_add_u32 s30, s30, s47
  s_add_u32 s33, s33, 40960
  s_cmp_eq_u32 s33, 163840
  s_cselect_b32 s33, 0, s33
  s_waitcnt lgkmcnt(5)
  v_mfma_f32_32x32x16_bf16 v[32:47], v[88:91], v[120:123], v[32:47]
  s_cmp_lt_u32 s35, 7
  s_cselect_b32 s10, s10, 0
  s_cselect_b32 s14, s14, 0
  s_cselect_b32 s18, s18, 0
  v_add_u32 v8, s34, v7
  v_add_u32 v15, s34, v12
  v_add_u32 v16, s34, v13
  v_xor_b32 v9, 32, v8
  v_xor_b32 v10, 64, v8
  v_xor_b32 v11, 96, v8
  s_add_u32 s34, s34, 40960
  s_cmp_eq_u32 s34, 163840
  s_cselect_b32 s34, 0, s34
  s_waitcnt vmcnt(5) lgkmcnt(0)
  s_barrier
  v_mfma_f32_32x32x16_bf16 v[48:63], v[88:91], v[124:127], v[48:63]
  ds_read_b128 v[80:83], v8
  ds_read_b64_tr_b16 v[96:97], v15 offset:0
  ds_read_b64_tr_b16 v[98:99], v15 offset:1280
  ds_read_b64_tr_b16 v[100:101], v16 offset:0
  ds_read_b64_tr_b16 v[102:103], v16 offset:1280
  s_add_u32 m0, s41, s33
  s_nop 0
  buffer_load_dwordx4 v2, s[8:11], s28 offen lds
  v_mfma_f32_32x32x16_bf16 v[32:47], v[92:95], v[132:135], v[32:47]
  ds_read_b128 v[84:87], v9
  ds_read_b64_tr_b16 v[108:109], v15 offset:5120
  ds_read_b64_tr_b16 v[110:111], v15 offset:6400
  ds_read_b64_tr_b16 v[112:113], v16 offset:5120
  ds_read_b64_tr_b16 v[114:115], v16 offset:6400
  s_add_u32 m0, s42, s33
  v_mfma_f32_32x32x16_bf16 v[48:63], v[92:95], v[136:139], v[48:63]
  s_add_u32 s6, s6, 1
  buffer_load_dwordx4 v3, s[8:11], s28 offen lds
  s_cmp_eq_u32 s6, 10
  s_cselect_b32 s46, -1152, s52
  s_cselect_b32 s6, 0, s6
  s_add_u32 s28, s28, s46
  s_add_u32 s35, s35, 1
  s_cmp_lt_u32 s35, 10
  s_cbranch_scc1 Lproj_V1_loop
  s_nop 7
  s_waitcnt lgkmcnt(0)
  s_nop 15
  v_cvt_pk_bf16_f32 v80, v32, v33
  v_cvt_pk_bf16_f32 v81, v34, v35
  v_cvt_pk_bf16_f32 v82, v36, v37
  v_cvt_pk_bf16_f32 v83, v38, v39
  v_cvt_pk_bf16_f32 v84, v40, v41
  v_cvt_pk_bf16_f32 v85, v42, v43
  v_cvt_pk_bf16_f32 v86, v44, v45
  v_cvt_pk_bf16_f32 v87, v46, v47
  v_add_u32 v18, 96, v21
  v_mul_u32_u24 v19, 205, v18
  v_lshrrev_b32 v19, 12, v19
  v_mul_u32_u24 v25, 20, v19
  v_sub_u32 v18, v18, v25
  v_and_b32 v25, 0x13, v18
  v_and_b32 v26, 4, v18
  v_lshl_or_b32 v25, v26, 1, v25
  v_and_b32 v26, 8, v18
  v_lshrrev_b32 v26, 1, v26
  v_or_b32 v25, v25, v26
  v_mul_u32_u24 v26, 320, v22
  v_lshl_add_u32 v25, v25, 4, v26
  s_mov_b32 s46, 163840
  v_mul_lo_u32 v19, v19, s46
  v_add_u32 v25, v25, v19
  s_sub_u32 s46, s25, 12
  s_mul_i32 s46, s46, 1310720
  s_add_u32 s46, s46, s49
  s_mul_i32 s47, s50, 1280
  s_add_u32 s46, s46, s47
  s_add_u32 s46, s46, 10240
  buffer_store_dwordx4 v[80:83], v25, s[20:23], s46 offen sc0 sc1
  buffer_store_dwordx4 v[84:87], v25, s[20:23], s46 offen offset:640 sc0 sc1
  v_cvt_pk_bf16_f32 v88, v48, v49
  v_cvt_pk_bf16_f32 v89, v50, v51
  v_cvt_pk_bf16_f32 v90, v52, v53
  v_cvt_pk_bf16_f32 v91, v54, v55
  v_cvt_pk_bf16_f32 v92, v56, v57
  v_cvt_pk_bf16_f32 v93, v58, v59
  v_cvt_pk_bf16_f32 v94, v60, v61
  v_cvt_pk_bf16_f32 v95, v62, v63
  v_add_u32 v18, 128, v21
  v_mul_u32_u24 v19, 205, v18
  v_lshrrev_b32 v19, 12, v19
  v_mul_u32_u24 v25, 20, v19
  v_sub_u32 v18, v18, v25
  v_and_b32 v25, 0x13, v18
  v_and_b32 v26, 4, v18
  v_lshl_or_b32 v25, v26, 1, v25
  v_and_b32 v26, 8, v18
  v_lshrrev_b32 v26, 1, v26
  v_or_b32 v25, v25, v26
  v_mul_u32_u24 v26, 320, v22
  v_lshl_add_u32 v25, v25, 4, v26
  s_mov_b32 s46, 163840
  v_mul_lo_u32 v19, v19, s46
  v_add_u32 v25, v25, v19
  s_sub_u32 s46, s25, 12
  s_mul_i32 s46, s46, 1310720
  s_add_u32 s46, s46, s49
  s_mul_i32 s47, s50, 1280
  s_add_u32 s46, s46, s47
  s_add_u32 s46, s46, 10240
  buffer_store_dwordx4 v[88:91], v25, s[20:23], s46 offen sc0 sc1
  buffer_store_dwordx4 v[92:95], v25, s[20:23], s46 offen offset:640 sc0 sc1
  s_endpgm
Lproj_Q1k:
  v_lshrrev_b32 v18, 2, v26
  v_mul_u32_u24 v18, 20, v18
  v_and_b32 v19, 1, v26
  v_lshl_add_u32 v18, v19, 1, v18
  v_bfe_u32 v19, v26, 1, 1
  v_add3_u32 v18, v18, v19, 15
  v_mul_u32_u24 v12, 320, v25
  v_lshl_add_u32 v12, v18, 3, v12
  v_add_u32 v12, 16384, v12
  v_mul_u32_u24 v18, 5, v26
  v_add_u32 v18, 4, v18
  v_mul_u32_u24 v13, 320, v25
  v_lshl_add_u32 v13, v18, 3, v13
  v_add_u32 v13, 16384, v13
  v_and_b32 v19, 1, v26
  v_lshlrev_b32 v18, 1, v19
  v_bfe_u32 v19, v26, 1, 1
  v_add_u32 v18, v18, v19
  v_cmp_lt_u32 vcc, 3, v26
  s_nop 1
  v_cndmask_b32 v18, v18, 4, vcc
  v_mul_u32_u24 v14, 40, v25
  v_lshl_add_u32 v14, v18, 3, v14
  v_add_u32 v14, 36864, v14
  v_add_u32 v8, s34, v7
  v_add_u32 v15, s34, v12
  v_add_u32 v16, s34, v13
  v_add_u32 v17, s34, v14
  v_xor_b32 v9, 32, v8
  v_xor_b32 v10, 64, v8
  v_xor_b32 v11, 96, v8
  s_add_u32 s34, s34, 40960
  s_cmp_eq_u32 s34, 163840
  s_cselect_b32 s34, 0, s34
  s_add_u32 m0, s41, s33
  s_nop 0
  buffer_load_dwordx4 v2, s[8:11], s28 offen lds
  s_add_u32 m0, s42, s33
  s_add_u32 s6, s6, 1
  buffer_load_dwordx4 v3, s[8:11], s28 offen lds
  s_cmp_eq_u32 s6, 10
  s_cselect_b32 s46, -1152, s52
  s_cselect_b32 s6, 0, s6
  s_add_u32 s28, s28, s46
  s_add_u32 m0, s43, s33
  s_nop 0
  buffer_load_dwordx4 v4, s[12:15], s29 offen lds
  s_add_u32 m0, s44, s33
  s_nop 0
  buffer_load_dwordx4 v5, s[12:15], s29 offen lds
  s_add_u32 m0, s45, s33
  s_add_u32 s7, s7, 1
  buffer_load_dwordx4 v6, s[16:19], s30 offen lds
  s_cmp_eq_u32 s7, 10
  s_cselect_b32 s46, s51, s31
  s_cselect_b32 s47, s3, s32
  s_cselect_b32 s7, 0, s7
  s_add_u32 s29, s29, s46
  s_add_u32 s30, s30, s47
  s_add_u32 s33, s33, 40960
  s_cmp_eq_u32 s33, 163840
  s_cselect_b32 s33, 0, s33
  s_add_u32 m0, s41, s33
  s_nop 0
  buffer_load_dwordx4 v2, s[8:11], s28 offen lds
  s_add_u32 m0, s42, s33
  s_add_u32 s6, s6, 1
  buffer_load_dwordx4 v3, s[8:11], s28 offen lds
  s_cmp_eq_u32 s6, 10
  s_cselect_b32 s46, -1152, s52
  s_cselect_b32 s6, 0, s6
  s_add_u32 s28, s28, s46
  s_waitcnt vmcnt(7)
  s_barrier
  ds_read_b128 v[80:83], v8
  ds_read_b64_tr_b16 v[96:97], v15 offset:0
  ds_read_b64_tr_b16 v[98:99], v15 offset:1280
  ds_read_b64_tr_b16 v[100:101], v16 offset:0
  ds_read_b64_tr_b16 v[102:103], v16 offset:1280
  ds_read_b64_tr_b16 v[104:105], v17 offset:0
  ds_read_b64_tr_b16 v[106:107], v17 offset:160
  ds_read_b128 v[84:87], v9
  ds_read_b64_tr_b16 v[108:109], v15 offset:5120
  ds_read_b64_tr_b16 v[110:111], v15 offset:6400
  ds_read_b64_tr_b16 v[112:113], v16 offset:5120
  ds_read_b64_tr_b16 v[114:115], v16 offset:6400
  ds_read_b64_tr_b16 v[116:117], v17 offset:640
  ds_read_b64_tr_b16 v[118:119], v17 offset:800
Lproj_Q1k_loop:
  s_waitcnt lgkmcnt(7)
  v_mfma_f32_32x32x16_bf16 v[32:47], v[96:99], v[80:83], v[32:47]
  ds_read_b128 v[88:91], v10
  ds_read_b64_tr_b16 v[120:121], v15 offset:10240
  ds_read_b64_tr_b16 v[122:123], v15 offset:11520
  ds_read_b64_tr_b16 v[124:125], v16 offset:10240
  v_mfma_f32_32x32x16_bf16 v[48:63], v[100:103], v[80:83], v[48:63]
  ds_read_b64_tr_b16 v[126:127], v16 offset:11520
  ds_read_b64_tr_b16 v[128:129], v17 offset:1280
  ds_read_b64_tr_b16 v[130:131], v17 offset:1440
  s_add_u32 m0, s43, s33
  v_mfma_f32_32x32x16_bf16 v[64:79], v[104:107], v[80:83], v[64:79]
  s_nop 0
  buffer_load_dwordx4 v4, s[12:15], s29 offen lds
  s_waitcnt lgkmcnt(7)
  v_mfma_f32_32x32x16_bf16 v[32:47], v[108:111], v[84:87], v[32:47]
  ds_read_b128 v[92:95], v11
  ds_read_b64_tr_b16 v[132:133], v15 offset:15360
  ds_read_b64_tr_b16 v[134:135], v15 offset:16640
  ds_read_b64_tr_b16 v[136:137], v16 offset:15360
  ds_read_b64_tr_b16 v[138:139], v16 offset:16640
  ds_read_b64_tr_b16 v[140:141], v17 offset:1920
  ds_read_b64_tr_b16 v[142:143], v17 offset:2080
  s_add_u32 m0, s44, s33
  v_mfma_f32_32x32x16_bf16 v[48:63], v[112:115], v[84:87], v[48:63]
  s_nop 0
  buffer_load_dwordx4 v5, s[12:15], s29 offen lds
  s_add_u32 m0, s45, s33
  s_add_u32 s7, s7, 1
  buffer_load_dwordx4 v6, s[16:19], s30 offen lds
  s_cmp_eq_u32 s7, 10
  s_cselect_b32 s46, s51, s31
  s_cselect_b32 s47, s3, s32
  v_mfma_f32_32x32x16_bf16 v[64:79], v[116:119], v[84:87], v[64:79]
  s_cselect_b32 s7, 0, s7
  s_add_u32 s29, s29, s46
  s_add_u32 s30, s30, s47
  s_add_u32 s33, s33, 40960
  s_cmp_eq_u32 s33, 163840
  s_cselect_b32 s33, 0, s33
  s_waitcnt lgkmcnt(7)
  v_mfma_f32_32x32x16_bf16 v[32:47], v[120:123], v[88:91], v[32:47]
  s_cmp_lt_u32 s35, 7
  s_cselect_b32 s10, s10, 0
  s_cselect_b32 s14, s14, 0
  s_cselect_b32 s18, s18, 0
  v_add_u32 v8, s34, v7
  v_add_u32 v15, s34, v12
  v_add_u32 v16, s34, v13
  v_add_u32 v17, s34, v14
  v_xor_b32 v9, 32, v8
  v_xor_b32 v10, 64, v8
  v_xor_b32 v11, 96, v8
  s_add_u32 s34, s34, 40960
  s_cmp_eq_u32 s34, 163840
  s_cselect_b32 s34, 0, s34
  s_waitcnt vmcnt(5) lgkmcnt(0)
  s_barrier
  v_mfma_f32_32x32x16_bf16 v[48:63], v[124:127], v[88:91], v[48:63]
  ds_read_b128 v[80:83], v8
  ds_read_b64_tr_b16 v[96:97], v15 offset:0
  ds_read_b64_tr_b16 v[98:99], v15 offset:1280
  ds_read_b64_tr_b16 v[100:101], v16 offset:0
  ds_read_b64_tr_b16 v[102:103], v16 offset:1280
  v_mfma_f32_32x32x16_bf16 v[64:79], v[128:131], v[88:91], v[64:79]
  ds_read_b64_tr_b16 v[104:105], v17 offset:0
  ds_read_b64_tr_b16 v[106:107], v17 offset:160
  s_add_u32 m0, s41, s33
  s_nop 0
  buffer_load_dwordx4 v2, s[8:11], s28 offen lds
  v_mfma_f32_32x32x16_bf16 v[32:47], v[132:135], v[92:95], v[32:47]
  ds_read_b128 v[84:87], v9
  ds_read_b64_tr_b16 v[108:109], v15 offset:5120
  ds_read_b64_tr_b16 v[110:111], v15 offset:6400
  ds_read_b64_tr_b16 v[112:113], v16 offset:5120
  ds_read_b64_tr_b16 v[114:115], v16 offset:6400
  v_mfma_f32_32x32x16_bf16 v[48:63], v[136:139], v[92:95], v[48:63]
  ds_read_b64_tr_b16 v[116:117], v17 offset:640
  ds_read_b64_tr_b16 v[118:119], v17 offset:800
  s_add_u32 m0, s42, s33
  s_add_u32 s6, s6, 1
  buffer_load_dwordx4 v3, s[8:11], s28 offen lds
  v_mfma_f32_32x32x16_bf16 v[64:79], v[140:143], v[92:95], v[64:79]
  s_cmp_eq_u32 s6, 10
  s_cselect_b32 s46, -1152, s52
  s_cselect_b32 s6, 0, s6
  s_add_u32 s28, s28, s46
  s_add_u32 s35, s35, 1
  s_cmp_lt_u32 s35, 10
  s_cbranch_scc1 Lproj_Q1k_loop
  s_nop 7
  s_waitcnt lgkmcnt(0)
  s_cmp_lt_u32 s25, 8
  s_cselect_b64 vcc, -1, 0
  v_cndmask_b32 v18, v27, v21, vcc
  v_lshlrev_b32 v23, 9, v22
  v_lshl_add_u32 v23, v18, 4, v23
  v_mul_lo_u32 v24, v22, s37
  v_lshl_add_u32 v24, v18, 3, v24
  s_mul_i32 s46, s25, 655360
  s_lshl_b32 s47, s36, 10
  s_add_u32 s38, s46, s47
  s_lshl_b32 s47, s36, 8
  s_add_u32 s39, s46, s47
  s_add_u32 s39, s39, 65536
  s_cmp_lt_u32 s25, 8
  s_cbranch_scc1 Lproj_Q1k_isq
  s_sub_u32 s46, s25, 8
  s_mul_i32 s46, s46, 1310720
  s_add_u32 s46, s46, s49
  s_lshl_b32 s47, s50, 10
  s_add_u32 s38, s46, s47
  s_lshl_b32 s47, s50, 8
  s_add_u32 s39, s46, s47
  s_add_u32 s39, s39, 8192
Lproj_Q1k_isq:
  v_mov_b32 v20, s40
  s_nop 4
  v_mul_f32 v32, v32, v20
  v_mul_f32 v33, v33, v20
  v_mul_f32 v34, v34, v20
  v_mul_f32 v35, v35, v20
  v_mul_f32 v36, v36, v20
  v_mul_f32 v37, v37, v20
  v_mul_f32 v38, v38, v20
  v_mul_f32 v39, v39, v20
  v_mul_f32 v40, v40, v20
  v_mul_f32 v41, v41, v20
  v_mul_f32 v42, v42, v20
  v_mul_f32 v43, v43, v20
  v_mul_f32 v44, v44, v20
  v_mul_f32 v45, v45, v20
  v_mul_f32 v46, v46, v20
  v_mul_f32 v47, v47, v20
  v_cvt_pk_bf16_f32 v80, v32, v33
  v_cvt_pk_bf16_f32 v81, v34, v35
  v_cvt_pk_bf16_f32 v82, v36, v37
  v_cvt_pk_bf16_f32 v83, v38, v39
  v_cvt_pk_bf16_f32 v84, v40, v41
  v_cvt_pk_bf16_f32 v85, v42, v43
  v_cvt_pk_bf16_f32 v86, v44, v45
  v_cvt_pk_bf16_f32 v87, v46, v47
  s_mul_i32 s46, s37, 3
  s_add_u32 s46, s46, s38
  buffer_store_dwordx4 v[80:83], v23, s[20:23], s46 offen sc0 sc1
  s_mul_i32 s46, s37, 7
  s_add_u32 s46, s46, s38
  buffer_store_dwordx4 v[84:87], v23, s[20:23], s46 offen sc0 sc1
  v_mul_f32 v48, v48, v20
  v_mul_f32 v49, v49, v20
  v_mul_f32 v50, v50, v20
  v_mul_f32 v51, v51, v20
  v_mul_f32 v52, v52, v20
  v_mul_f32 v53, v53, v20
  v_mul_f32 v54, v54, v20
  v_mul_f32 v55, v55, v20
  v_mul_f32 v56, v56, v20
  v_mul_f32 v57, v57, v20
  v_mul_f32 v58, v58, v20
  v_mul_f32 v59, v59, v20
  v_mul_f32 v60, v60, v20
  v_mul_f32 v61, v61, v20
  v_mul_f32 v62, v62, v20
  v_mul_f32 v63, v63, v20
  v_cvt_pk_bf16_f32 v88, v48, v49
  v_cvt_pk_bf16_f32 v89, v50, v51
  v_cvt_pk_bf16_f32 v90, v52, v53
  v_cvt_pk_bf16_f32 v91, v54, v55
  v_cvt_pk_bf16_f32 v92, v56, v57
  v_cvt_pk_bf16_f32 v93, v58, v59
  v_cvt_pk_bf16_f32 v94, v60, v61
  v_cvt_pk_bf16_f32 v95, v62, v63
  s_mul_i32 s46, s37, 0
  s_add_u32 s46, s46, s39
  buffer_store_dwordx2 v[88:89], v24, s[20:23], s46 offen sc0 sc1
  s_mul_i32 s46, s37, 2
  s_add_u32 s46, s46, s39
  buffer_store_dwordx2 v[90:91], v24, s[20:23], s46 offen sc0 sc1
  s_mul_i32 s46, s37, 4
  s_add_u32 s46, s46, s39
  buffer_store_dwordx2 v[92:93], v24, s[20:23], s46 offen sc0 sc1
  s_mul_i32 s46, s37, 6
  s_add_u32 s46, s46, s39
  buffer_store_dwordx2 v[94:95], v24, s[20:23], s46 offen sc0 sc1
  v_cvt_pk_bf16_f32 v96, v64, v65
  v_cvt_pk_bf16_f32 v97, v66, v67
  v_cvt_pk_bf16_f32 v98, v68, v69
  v_cvt_pk_bf16_f32 v99, v70, v71
  v_cvt_pk_bf16_f32 v100, v72, v73
  v_cvt_pk_bf16_f32 v101, v74, v75
  v_cvt_pk_bf16_f32 v102, v76, v77
  v_cvt_pk_bf16_f32 v103, v78, v79
  v_lshlrev_b32 v18, 9, v22
  v_lshl_add_u32 v18, v27, 4, v18
  v_lshlrev_b32 v19, 3, v27
  s_add_u32 s46, s49, 5242880
  s_lshl_b32 s47, s50, 10
  s_add_u32 s47, s47, s46
  buffer_store_dwordx4 v[96:99], v18, s[20:23], s47 offen sc0 sc1
  s_lshl_b32 s47, s50, 8
  s_add_u32 s47, s47, s46
  s_add_u32 s47, s47, 8192
  s_mov_b32 exec_hi, 0
  buffer_store_dwordx2 v[100:101], v19, s[20:23], s47 offen sc0 sc1
  s_endpgm
Lproj_Q1v:
  v_lshrrev_b32 v18, 2, v26
  v_mul_u32_u24 v18, 20, v18
  v_and_b32 v19, 1, v26
  v_lshl_add_u32 v18, v19, 1, v18
  v_bfe_u32 v19, v26, 1, 1
  v_add3_u32 v18, v18, v19, 15
  v_mul_u32_u24 v12, 320, v25
  v_lshl_add_u32 v12, v18, 3, v12
  v_add_u32 v12, 16384, v12
  v_mul_u32_u24 v18, 5, v26
  v_add_u32 v18, 4, v18
  v_mul_u32_u24 v13, 320, v25
  v_lshl_add_u32 v13, v18, 3, v13
  v_add_u32 v13, 16384, v13
  v_min_u32 v18, 4, v26
  v_mul_u32_u24 v14, 40, v25
  v_lshl_add_u32 v14, v18, 3, v14
  v_add_u32 v14, 36864, v14
  v_add_u32 v8, s34, v7
  v_add_u32 v15, s34, v12
  v_add_u32 v16, s34, v13
  v_add_u32 v17, s34, v14
  v_xor_b32 v9, 32, v8
  v_xor_b32 v10, 64, v8
  v_xor_b32 v11, 96, v8
  s_add_u32 s34, s34, 40960
  s_cmp_eq_u32 s34, 163840
  s_cselect_b32 s34, 0, s34
  s_add_u32 m0, s41, s33
  s_nop 0
  buffer_load_dwordx4 v2, s[8:11], s28 offen lds
  s_add_u32 m0, s42, s33
  s_add_u32 s6, s6, 1
  buffer_load_dwordx4 v3, s[8:11], s28 offen lds
  s_cmp_eq_u32 s6, 10
  s_cselect_b32 s46, -1152, s52
  s_cselect_b32 s6, 0, s6
  s_add_u32 s28, s28, s46
  s_add_u32 m0, s43, s33
  s_nop 0
  buffer_load_dwordx4 v4, s[12:15], s29 offen lds
  s_add_u32 m0, s44, s33
  s_nop 0
  buffer_load_dwordx4 v5, s[12:15], s29 offen lds
  s_add_u32 m0, s45, s33
  s_add_u32 s7, s7, 1
  buffer_load_dwordx4 v6, s[16:19], s30 offen lds
  s_cmp_eq_u32 s7, 10
  s_cselect_b32 s46, s51, s31
  s_cselect_b32 s47, s3, s32
  s_cselect_b32 s7, 0, s7
  s_add_u32 s29, s29, s46
  s_add_u32 s30, s30, s47
  s_add_u32 s33, s33, 40960
  s_cmp_eq_u32 s33, 163840
  s_cselect_b32 s33, 0, s33
  s_add_u32 m0, s41, s33
  s_nop 0
  buffer_load_dwordx4 v2, s[8:11], s28 offen lds
  s_add_u32 m0, s42, s33
  s_add_u32 s6, s6, 1
  buffer_load_dwordx4 v3, s[8:11], s28 offen lds
  s_cmp_eq_u32 s6, 10
  s_cselect_b32 s46, -1152, s52
  s_cselect_b32 s6, 0, s6
  s_add_u32 s28, s28, s46
  s_waitcnt vmcnt(7)
  s_barrier
  ds_read_b128 v[80:83], v8
  ds_read_b64_tr_b16 v[96:97], v15 offset:0
  ds_read_b64_tr_b16 v[98:99], v15 offset:1280
  ds_read_b64_tr_b16 v[100:101], v16 offset:0
  ds_read_b64_tr_b16 v[102:103], v16 offset:1280
  ds_read_b64_tr_b16 v[104:105], v17 offset:0
  ds_read_b64_tr_b16 v[106:107], v17 offset:160
  ds_read_b128 v[84:87], v9
  ds_read_b64_tr_b16 v[108:109], v15 offset:5120
  ds_read_b64_tr_b16 v[110:111], v15 offset:6400
  ds_read_b64_tr_b16 v[112:113], v16 offset:5120
  ds_read_b64_tr_b16 v[114:115], v16 offset:6400
  ds_read_b64_tr_b16 v[116:117], v17 offset:640
  ds_read_b64_tr_b16 v[118:119], v17 offset:800
Lproj_Q1v_loop:
  s_waitcnt lgkmcnt(7)
  v_mfma_f32_32x32x16_bf16 v[32:47], v[96:99], v[80:83], v[32:47]
  ds_read_b128 v[88:91], v10
  ds_read_b64_tr_b16 v[120:121], v15 offset:10240
  ds_read_b64_tr_b16 v[122:123], v15 offset:11520
  ds_read_b64_tr_b16 v[124:125], v16 offset:10240
  v_mfma_f32_32x32x16_bf16 v[48:63], v[100:103], v[80:83], v[48:63]
  ds_read_b64_tr_b16 v[126:127], v16 offset:11520
  ds_read_b64_tr_b16 v[128:129], v17 offset:1280
  ds_read_b64_tr_b16 v[130:131], v17 offset:1440
  s_add_u32 m0, s43, s33
  v_mfma_f32_32x32x16_bf16 v[64:79], v[80:83], v[104:107], v[64:79]
  s_nop 0
  buffer_load_dwordx4 v4, s[12:15], s29 offen lds
  s_waitcnt lgkmcnt(7)
  v_mfma_f32_32x32x16_bf16 v[32:47], v[108:111], v[84:87], v[32:47]
  ds_read_b128 v[92:95], v11
  ds_read_b64_tr_b16 v[132:133], v15 offset:15360
  ds_read_b64_tr_b16 v[134:135], v15 offset:16640
  ds_read_b64_tr_b16 v[136:137], v16 offset:15360
  ds_read_b64_tr_b16 v[138:139], v16 offset:16640
  ds_read_b64_tr_b16 v[140:141], v17 offset:1920
  ds_read_b64_tr_b16 v[142:143], v17 offset:2080
  s_add_u32 m0, s44, s33
  v_mfma_f32_32x32x16_bf16 v[48:63], v[112:115], v[84:87], v[48:63]
  s_nop 0
  buffer_load_dwordx4 v5, s[12:15], s29 offen lds
  s_add_u32 m0, s45, s33
  s_add_u32 s7, s7, 1
  buffer_load_dwordx4 v6, s[16:19], s30 offen lds
  s_cmp_eq_u32 s7, 10
  s_cselect_b32 s46, s51, s31
  s_cselect_b32 s47, s3, s32
  v_mfma_f32_32x32x16_bf16 v[64:79], v[84:87], v[116:119], v[64:79]
  s_cselect_b32 s7, 0, s7
  s_add_u32 s29, s29, s46
  s_add_u32 s30, s30, s47
  s_add_u32 s33, s33, 40960
  s_cmp_eq_u32 s33, 163840
  s_cselect_b32 s33, 0, s33
  s_waitcnt lgkmcnt(7)
  v_mfma_f32_32x32x16_bf16 v[32:47], v[120:123], v[88:91], v[32:47]
  s_cmp_lt_u32 s35, 7
  s_cselect_b32 s10, s10, 0
  s_cselect_b32 s14, s14, 0
  s_cselect_b32 s18, s18, 0
  v_add_u32 v8, s34, v7
  v_add_u32 v15, s34, v12
  v_add_u32 v16, s34, v13
  v_add_u32 v17, s34, v14
  v_xor_b32 v9, 32, v8
  v_xor_b32 v10, 64, v8
  v_xor_b32 v11, 96, v8
  s_add_u32 s34, s34, 40960
  s_cmp_eq_u32 s34, 163840
  s_cselect_b32 s34, 0, s34
  s_waitcnt vmcnt(5) lgkmcnt(0)
  s_barrier
  v_mfma_f32_32x32x16_bf16 v[48:63], v[124:127], v[88:91], v[48:63]
  ds_read_b128 v[80:83], v8
  ds_read_b64_tr_b16 v[96:97], v15 offset:0
  ds_read_b64_tr_b16 v[98:99], v15 offset:1280
  ds_read_b64_tr_b16 v[100:101], v16 offset:0
  ds_read_b64_tr_b16 v[102:103], v16 offset:1280
  v_mfma_f32_32x32x16_bf16 v[64:79], v[88:91], v[128:131], v[64:79]
  ds_read_b64_tr_b16 v[104:105], v17 offset:0
  ds_read_b64_tr_b16 v[106:107], v17 offset:160
  s_add_u32 m0, s41, s33
  s_nop 0
  buffer_load_dwordx4 v2, s[8:11], s28 offen lds
  v_mfma_f32_32x32x16_bf16 v[32:47], v[132:135], v[92:95], v[32:47]
  ds_read_b128 v[84:87], v9
  ds_read_b64_tr_b16 v[108:109], v15 offset:5120
  ds_read_b64_tr_b16 v[110:111], v15 offset:6400
  ds_read_b64_tr_b16 v[112:113], v16 offset:5120
  ds_read_b64_tr_b16 v[114:115], v16 offset:6400
  v_mfma_f32_32x32x16_bf16 v[48:63], v[136:139], v[92:95], v[48:63]
  ds_read_b64_tr_b16 v[116:117], v17 offset:640
  ds_read_b64_tr_b16 v[118:119], v17 offset:800
  s_add_u32 m0, s42, s33
  s_add_u32 s6, s6, 1
  buffer_load_dwordx4 v3, s[8:11], s28 offen lds
  v_mfma_f32_32x32x16_bf16 v[64:79], v[92:95], v[140:143], v[64:79]
  s_cmp_eq_u32 s6, 10
  s_cselect_b32 s46, -1152, s52
  s_cselect_b32 s6, 0, s6
  s_add_u32 s28, s28, s46
  s_add_u32 s35, s35, 1
  s_cmp_lt_u32 s35, 10
  s_cbranch_scc1 Lproj_Q1v_loop
  s_nop 7
  s_waitcnt lgkmcnt(0)
  s_cmp_lt_u32 s25, 8
  s_cselect_b64 vcc, -1, 0
  v_cndmask_b32 v18, v27, v21, vcc
  v_lshlrev_b32 v23, 9, v22
  v_lshl_add_u32 v23, v18, 4, v23
  v_mul_lo_u32 v24, v22, s37
  v_lshl_add_u32 v24, v18, 3, v24
  s_mul_i32 s46, s25, 655360
  s_lshl_b32 s47, s36, 10
  s_add_u32 s38, s46, s47
  s_lshl_b32 s47, s36, 8
  s_add_u32 s39, s46, s47
  s_add_u32 s39, s39, 65536
  s_cmp_lt_u32 s25, 8
  s_cbranch_scc1 Lproj_Q1v_isq
  s_sub_u32 s46, s25, 8
  s_mul_i32 s46, s46, 1310720
  s_add_u32 s46, s46, s49
  s_lshl_b32 s47, s50, 10
  s_add_u32 s38, s46, s47
  s_lshl_b32 s47, s50, 8
  s_add_u32 s39, s46, s47
  s_add_u32 s39, s39, 8192
Lproj_Q1v_isq:
  v_mov_b32 v20, s40
  s_nop 4
  v_mul_f32 v32, v32, v20
  v_mul_f32 v33, v33, v20
  v_mul_f32 v34, v34, v20
  v_mul_f32 v35, v35, v20
  v_mul_f32 v36, v36, v20
  v_mul_f32 v37, v37, v20
  v_mul_f32 v38, v38, v20
  v_mul_f32 v39, v39, v20
  v_mul_f32 v40, v40, v20
  v_mul_f32 v41, v41, v20
  v_mul_f32 v42, v42, v20
  v_mul_f32 v43, v43, v20
  v_mul_f32 v44, v44, v20
  v_mul_f32 v45, v45, v20
  v_mul_f32 v46, v46, v20
  v_mul_f32 v47, v47, v20
  v_cvt_pk_bf16_f32 v80, v32, v33
  v_cvt_pk_bf16_f32 v81, v34, v35
  v_cvt_pk_bf16_f32 v82, v36, v37
  v_cvt_pk_bf16_f32 v83, v38, v39
  v_cvt_pk_bf16_f32 v84, v40, v41
  v_cvt_pk_bf16_f32 v85, v42, v43
  v_cvt_pk_bf16_f32 v86, v44, v45
  v_cvt_pk_bf16_f32 v87, v46, v47
  s_mul_i32 s46, s37, 3
  s_add_u32 s46, s46, s38
  buffer_store_dwordx4 v[80:83], v23, s[20:23], s46 offen sc0 sc1
  s_mul_i32 s46, s37, 7
  s_add_u32 s46, s46, s38
  buffer_store_dwordx4 v[84:87], v23, s[20:23], s46 offen sc0 sc1
  v_mul_f32 v48, v48, v20
  v_mul_f32 v49, v49, v20
  v_mul_f32 v50, v50, v20
  v_mul_f32 v51, v51, v20
  v_mul_f32 v52, v52, v20
  v_mul_f32 v53, v53, v20
  v_mul_f32 v54, v54, v20
  v_mul_f32 v55, v55, v20
  v_mul_f32 v56, v56, v20
  v_mul_f32 v57, v57, v20
  v_mul_f32 v58, v58, v20
  v_mul_f32 v59, v59, v20
  v_mul_f32 v60, v60, v20
  v_mul_f32 v61, v61, v20
  v_mul_f32 v62, v62, v20
  v_mul_f32 v63, v63, v20
  v_cvt_pk_bf16_f32 v88, v48, v49
  v_cvt_pk_bf16_f32 v89, v50, v51
  v_cvt_pk_bf16_f32 v90, v52, v53
  v_cvt_pk_bf16_f32 v91, v54, v55
  v_cvt_pk_bf16_f32 v92, v56, v57
  v_cvt_pk_bf16_f32 v93, v58, v59
  v_cvt_pk_bf16_f32 v94, v60, v61
  v_cvt_pk_bf16_f32 v95, v62, v63
  s_mul_i32 s46, s37, 0
  s_add_u32 s46, s46, s39
  buffer_store_dwordx2 v[88:89], v24, s[20:23], s46 offen sc0 sc1
  s_mul_i32 s46, s37, 2
  s_add_u32 s46, s46, s39
  buffer_store_dwordx2 v[90:91], v24, s[20:23], s46 offen sc0 sc1
  s_mul_i32 s46, s37, 4
  s_add_u32 s46, s46, s39
  buffer_store_dwordx2 v[92:93], v24, s[20:23], s46 offen sc0 sc1
  s_mul_i32 s46, s37, 6
  s_add_u32 s46, s46, s39
  buffer_store_dwordx2 v[94:95], v24, s[20:23], s46 offen sc0 sc1
  v_cvt_pk_bf16_f32 v96, v64, v65
  v_cvt_pk_bf16_f32 v97, v66, v67
  v_cvt_pk_bf16_f32 v98, v68, v69
  v_cvt_pk_bf16_f32 v99, v70, v71
  v_cvt_pk_bf16_f32 v100, v72, v73
  v_cvt_pk_bf16_f32 v101, v74, v75
  v_cvt_pk_bf16_f32 v102, v76, v77
  v_cvt_pk_bf16_f32 v103, v78, v79
  v_mov_b32 v18, v21
  v_and_b32 v25, 0x13, v18
  v_and_b32 v26, 4, v18
  v_lshl_or_b32 v25, v26, 1, v25
  v_and_b32 v26, 8, v18
  v_lshrrev_b32 v26, 1, v26
  v_or_b32 v25, v25, v26
  v_mul_u32_u24 v26, 320, v22
  v_lshl_add_u32 v25, v25, 4, v26
  s_mov_b32 s46, 5242880
  v_cmp_gt_u32 vcc, 20, v21
  s_nop 1
  s_and_b64 exec, exec, vcc
  s_add_u32 s46, s46, s49
  s_mul_i32 s47, s50, 1280
  s_add_u32 s46, s46, s47
  s_add_u32 s46, s46, 10240
  buffer_store_dwordx4 v[96:99], v25, s[20:23], s46 offen sc0 sc1
  buffer_store_dwordx4 v[100:103], v25, s[20:23], s46 offen offset:640 sc0 sc1
  s_endpgm
Lproj_Q1g:
  v_lshrrev_b32 v18, 2, v26
  v_mul_u32_u24 v18, 20, v18
  v_and_b32 v19, 1, v26
  v_lshl_add_u32 v18, v19, 1, v18
  v_bfe_u32 v19, v26, 1, 1
  v_add3_u32 v18, v18, v19, 15
  v_mul_u32_u24 v12, 320, v25
  v_lshl_add_u32 v12, v18, 3, v12
  v_add_u32 v12, 16384, v12
  v_mul_u32_u24 v18, 5, v26
  v_add_u32 v18, 4, v18
  v_mul_u32_u24 v13, 320, v25
  v_lshl_add_u32 v13, v18, 3, v13
  v_add_u32 v13, 16384, v13
  v_lshlrev_b32 v14, 4, v22
  v_add_u32 v14, 36864, v14
  v_add_u32 v8, s34, v7
  v_add_u32 v15, s34, v12
  v_add_u32 v16, s34, v13
  v_add_u32 v17, s34, v14
  v_xor_b32 v9, 32, v8
  v_xor_b32 v10, 64, v8
  v_xor_b32 v11, 96, v8
  s_add_u32 s34, s34, 40960
  s_cmp_eq_u32 s34, 163840
  s_cselect_b32 s34, 0, s34
  s_add_u32 m0, s41, s33
  s_nop 0
  buffer_load_dwordx4 v2, s[8:11], s28 offen lds
  s_add_u32 m0, s42, s33
  s_add_u32 s6, s6, 1
  buffer_load_dwordx4 v3, s[8:11], s28 offen lds
  s_cmp_eq_u32 s6, 10
  s_cselect_b32 s46, -1152, s52
  s_cselect_b32 s6, 0, s6
  s_add_u32 s28, s28, s46
  s_add_u32 m0, s43, s33
  s_nop 0
  buffer_load_dwordx4 v4, s[12:15], s29 offen lds
  s_add_u32 m0, s44, s33
  s_nop 0
  buffer_load_dwordx4 v5, s[12:15], s29 offen lds
  s_add_u32 m0, s45, s33
  s_add_u32 s7, s7, 1
  buffer_load_dwordx4 v6, s[16:19], s30 offen lds
  s_cmp_eq_u32 s7, 10
  s_cselect_b32 s46, s51, s31
  s_cselect_b32 s47, s3, s32
  s_cselect_b32 s7, 0, s7
  s_add_u32 s29, s29, s46
  s_add_u32 s30, s30, s47
  s_add_u32 s33, s33, 40960
  s_cmp_eq_u32 s33, 163840
  s_cselect_b32 s33, 0, s33
  s_add_u32 m0, s41, s33
  s_nop 0
  buffer_load_dwordx4 v2, s[8:11], s28 offen lds
  s_add_u32 m0, s42, s33
  s_add_u32 s6, s6, 1
  buffer_load_dwordx4 v3, s[8:11], s28 offen lds
  s_cmp_eq_u32 s6, 10
  s_cselect_b32 s46, -1152, s52
  s_cselect_b32 s6, 0, s6
  s_add_u32 s28, s28, s46
  s_waitcnt vmcnt(7)
  s_barrier
  ds_read_b128 v[80:83], v8
  ds_read_b64_tr_b16 v[96:97], v15 offset:0
  ds_read_b64_tr_b16 v[98:99], v15 offset:1280
  ds_read_b64_tr_b16 v[100:101], v16 offset:0
  ds_read_b64_tr_b16 v[102:103], v16 offset:1280
  ds_read_b128 v[104:107], v17 offset:0
  ds_read_b128 v[84:87], v9
  ds_read_b64_tr_b16 v[108:109], v15 offset:5120
  ds_read_b64_tr_b16 v[110:111], v15 offset:6400
  ds_read_b64_tr_b16 v[112:113], v16 offset:5120
  ds_read_b64_tr_b16 v[114:115], v16 offset:6400
  ds_read_b128 v[116:119], v17 offset:32
Lproj_Q1g_loop:
  s_waitcnt lgkmcnt(6)
  v_mfma_f32_32x32x16_bf16 v[32:47], v[96:99], v[80:83], v[32:47]
  ds_read_b128 v[88:91], v10
  ds_read_b64_tr_b16 v[120:121], v15 offset:10240
  ds_read_b64_tr_b16 v[122:123], v15 offset:11520
  v_mfma_f32_32x32x16_bf16 v[48:63], v[100:103], v[80:83], v[48:63]
  ds_read_b64_tr_b16 v[124:125], v16 offset:10240
  ds_read_b64_tr_b16 v[126:127], v16 offset:11520
  ds_read_b128 v[128:131], v17 offset:64
  v_mfma_f32_32x32x16_bf16 v[64:79], v[104:107], v[80:83], v[64:79]
  s_add_u32 m0, s43, s33
  s_nop 0
  buffer_load_dwordx4 v4, s[12:15], s29 offen lds
  s_waitcnt lgkmcnt(6)
  v_mfma_f32_32x32x16_bf16 v[32:47], v[108:111], v[84:87], v[32:47]
  ds_read_b128 v[92:95], v11
  ds_read_b64_tr_b16 v[132:133], v15 offset:15360
  ds_read_b64_tr_b16 v[134:135], v15 offset:16640
  ds_read_b64_tr_b16 v[136:137], v16 offset:15360
  ds_read_b64_tr_b16 v[138:139], v16 offset:16640
  ds_read_b128 v[140:143], v17 offset:96
  s_add_u32 m0, s44, s33
  v_mfma_f32_32x32x16_bf16 v[48:63], v[112:115], v[84:87], v[48:63]
  s_nop 0
  buffer_load_dwordx4 v5, s[12:15], s29 offen lds
  s_add_u32 m0, s45, s33
  s_add_u32 s7, s7, 1
  buffer_load_dwordx4 v6, s[16:19], s30 offen lds
  s_cmp_eq_u32 s7, 10
  s_cselect_b32 s46, s51, s31
  v_mfma_f32_32x32x16_bf16 v[64:79], v[116:119], v[84:87], v[64:79]
  s_cselect_b32 s47, s3, s32
  s_cselect_b32 s7, 0, s7
  s_add_u32 s29, s29, s46
  s_add_u32 s30, s30, s47
  s_add_u32 s33, s33, 40960
  s_cmp_eq_u32 s33, 163840
  s_cselect_b32 s33, 0, s33
  s_waitcnt lgkmcnt(6)
  v_mfma_f32_32x32x16_bf16 v[32:47], v[120:123], v[88:91], v[32:47]
  s_cmp_lt_u32 s35, 7
  s_cselect_b32 s10, s10, 0
  s_cselect_b32 s14, s14, 0
  s_cselect_b32 s18, s18, 0
  v_add_u32 v8, s34, v7
  v_add_u32 v15, s34, v12
  v_add_u32 v16, s34, v13
  v_add_u32 v17, s34, v14
  v_xor_b32 v9, 32, v8
  v_xor_b32 v10, 64, v8
  v_xor_b32 v11, 96, v8
  s_add_u32 s34, s34, 40960
  s_cmp_eq_u32 s34, 163840
  s_cselect_b32 s34, 0, s34
  s_waitcnt vmcnt(5) lgkmcnt(0)
  s_barrier
  v_mfma_f32_32x32x16_bf16 v[48:63], v[124:127], v[88:91], v[48:63]
  ds_read_b128 v[80:83], v8
  ds_read_b64_tr_b16 v[96:97], v15 offset:0
  ds_read_b64_tr_b16 v[98:99], v15 offset:1280
  ds_read_b64_tr_b16 v[100:101], v16 offset:0
  ds_read_b64_tr_b16 v[102:103], v16 offset:1280
  v_mfma_f32_32x32x16_bf16 v[64:79], v[128:131], v[88:91], v[64:79]
  ds_read_b128 v[104:107], v17 offset:0
  s_add_u32 m0, s41, s33
  s_nop 0
  buffer_load_dwordx4 v2, s[8:11], s28 offen lds
  v_mfma_f32_32x32x16_bf16 v[32:47], v[132:135], v[92:95], v[32:47]
  ds_read_b128 v[84:87], v9
  ds_read_b64_tr_b16 v[108:109], v15 offset:5120
  ds_read_b64_tr_b16 v[110:111], v15 offset:6400
  ds_read_b64_tr_b16 v[112:113], v16 offset:5120
  ds_read_b64_tr_b16 v[114:115], v16 offset:6400
  v_mfma_f32_32x32x16_bf16 v[48:63], v[136:139], v[92:95], v[48:63]
  ds_read_b128 v[116:119], v17 offset:32
  s_add_u32 m0, s42, s33
  s_add_u32 s6, s6, 1
  buffer_load_dwordx4 v3, s[8:11], s28 offen lds
  s_cmp_eq_u32 s6, 10
  v_mfma_f32_32x32x16_bf16 v[64:79], v[140:143], v[92:95], v[64:79]
  s_cselect_b32 s46, -1152, s52
  s_cselect_b32 s6, 0, s6
  s_add_u32 s28, s28, s46
  s_add_u32 s35, s35, 1
  s_cmp_lt_u32 s35, 10
  s_cbranch_scc1 Lproj_Q1g_loop
  s_nop 7
  s_waitcnt lgkmcnt(0)
  s_cmp_lt_u32 s25, 8
  s_cselect_b64 vcc, -1, 0
  v_cndmask_b32 v18, v27, v21, vcc
  v_lshlrev_b32 v23, 9, v22
  v_lshl_add_u32 v23, v18, 4, v23
  v_mul_lo_u32 v24, v22, s37
  v_lshl_add_u32 v24, v18, 3, v24
  s_mul_i32 s46, s25, 655360
  s_lshl_b32 s47, s36, 10
  s_add_u32 s38, s46, s47
  s_lshl_b32 s47, s36, 8
  s_add_u32 s39, s46, s47
  s_add_u32 s39, s39, 65536
  s_cmp_lt_u32 s25, 8
  s_cbranch_scc1 Lproj_Q1g_isq
  s_sub_u32 s46, s25, 8
  s_mul_i32 s46, s46, 1310720
  s_add_u32 s46, s46, s49
  s_lshl_b32 s47, s50, 10
  s_add_u32 s38, s46, s47
  s_lshl_b32 s47, s50, 8
  s_add_u32 s39, s46, s47
  s_add_u32 s39, s39, 8192
Lproj_Q1g_isq:
  v_mov_b32 v20, s40
  s_nop 4
  v_mul_f32 v32, v32, v20
  v_mul_f32 v33, v33, v20
  v_mul_f32 v34, v34, v20
  v_mul_f32 v35, v35, v20
  v_mul_f32 v36, v36, v20
  v_mul_f32 v37, v37, v20
  v_mul_f32 v38, v38, v20
  v_mul_f32 v39, v39, v20
  v_mul_f32 v40, v40, v20
  v_mul_f32 v41, v41, v20
  v_mul_f32 v42, v42, v20
  v_mul_f32 v43, v43, v20
  v_mul_f32 v44, v44, v20
  v_mul_f32 v45, v45, v20
  v_mul_f32 v46, v46, v20
  v_mul_f32 v47, v47, v20
  v_cvt_pk_bf16_f32 v80, v32, v33
  v_cvt_pk_bf16_f32 v81, v34, v35
  v_cvt_pk_bf16_f32 v82, v36, v37
  v_cvt_pk_bf16_f32 v83, v38, v39
  v_cvt_pk_bf16_f32 v84, v40, v41
  v_cvt_pk_bf16_f32 v85, v42, v43
  v_cvt_pk_bf16_f32 v86, v44, v45
  v_cvt_pk_bf16_f32 v87, v46, v47
  s_mul_i32 s46, s37, 3
  s_add_u32 s46, s46, s38
  buffer_store_dwordx4 v[80:83], v23, s[20:23], s46 offen sc0 sc1
  s_mul_i32 s46, s37, 7
  s_add_u32 s46, s46, s38
  buffer_store_dwordx4 v[84:87], v23, s[20:23], s46 offen sc0 sc1
  v_mul_f32 v48, v48, v20
  v_mul_f32 v49, v49, v20
  v_mul_f32 v50, v50, v20
  v_mul_f32 v51, v51, v20
  v_mul_f32 v52, v52, v20
  v_mul_f32 v53, v53, v20
  v_mul_f32 v54, v54, v20
  v_mul_f32 v55, v55, v20
  v_mul_f32 v56, v56, v20
  v_mul_f32 v57, v57, v20
  v_mul_f32 v58, v58, v20
  v_mul_f32 v59, v59, v20
  v_mul_f32 v60, v60, v20
  v_mul_f32 v61, v61, v20
  v_mul_f32 v62, v62, v20
  v_mul_f32 v63, v63, v20
  v_cvt_pk_bf16_f32 v88, v48, v49
  v_cvt_pk_bf16_f32 v89, v50, v51
  v_cvt_pk_bf16_f32 v90, v52, v53
  v_cvt_pk_bf16_f32 v91, v54, v55
  v_cvt_pk_bf16_f32 v92, v56, v57
  v_cvt_pk_bf16_f32 v93, v58, v59
  v_cvt_pk_bf16_f32 v94, v60, v61
  v_cvt_pk_bf16_f32 v95, v62, v63
  s_mul_i32 s46, s37, 0
  s_add_u32 s46, s46, s39
  buffer_store_dwordx2 v[88:89], v24, s[20:23], s46 offen sc0 sc1
  s_mul_i32 s46, s37, 2
  s_add_u32 s46, s46, s39
  buffer_store_dwordx2 v[90:91], v24, s[20:23], s46 offen sc0 sc1
  s_mul_i32 s46, s37, 4
  s_add_u32 s46, s46, s39
  buffer_store_dwordx2 v[92:93], v24, s[20:23], s46 offen sc0 sc1
  s_mul_i32 s46, s37, 6
  s_add_u32 s46, s46, s39
  buffer_store_dwordx2 v[94:95], v24, s[20:23], s46 offen sc0 sc1
  v_cvt_pk_bf16_f32 v18, v64, v64
  v_lshlrev_b32 v18, 16, v18
  v_mul_f32 v18, 0xbfb8aa3b, v18
  v_exp_f32 v18, v18
  s_nop 0
  v_add_f32 v18, 1.0, v18
  v_rcp_f32 v18, v18
  s_nop 0
  v_cvt_pk_bf16_f32 v18, v18, v18
  v_lshlrev_b32 v18, 16, v18
  v_sub_f32 v19, 1.0, v18
  v_cvt_pk_bf16_f32 v19, v19, v19
  v_lshlrev_b32 v19, 16, v19
  v_lshlrev_b32 v25, 2, v21
  s_lshl_b32 s46, s36, 7
  s_add_u32 s46, s46, 10649600
  s_add_u32 s47, s46, 8192
  s_mov_b32 exec_hi, 0
  buffer_store_dword v18, v25, s[20:23], s46 offen sc0 sc1
  buffer_store_dword v19, v25, s[20:23], s47 offen sc0 sc1
  s_endpgm
Lproj_end:
  s_endpgm
.globl attn_kernel
.p2align 8
.type attn_kernel,@function
attn_kernel:
  s_cmp_ge_u32 s2, 256
  s_cbranch_scc1 Lattn_end
  s_load_dwordx2 s[4:5], s[0:1], 88
  s_load_dwordx2 s[6:7], s[0:1], 32
  s_load_dwordx2 s[38:39], s[0:1], 56
  v_and_b32 v12, 63, v0
  v_lshrrev_b32 v8, 6, v0
  v_lshlrev_b32 v5, 4, v12
  v_readfirstlane_b32 s15, v8
  s_and_b32 s16, s2, 7
  s_lshr_b32 s17, s2, 3
  s_and_b32 s13, s17, 3
  s_lshr_b32 s17, s17, 2
  s_lshl_b32 s16, s16, 2
  s_and_b32 s23, s17, 3
  s_add_u32 s16, s16, s23
  s_lshr_b32 s17, s17, 2
  s_lshl_b32 s23, s17, 5
  s_add_u32 s12, s16, s23
  s_cmp_eq_u32 s17, 0
  s_cselect_b32 s14, 32, s16
  s_mul_i32 s14, s14, 163840
  s_add_u32 s14, s14, 5242880
  s_lshl_b32 s32, s15, 10
  s_add_u32 s33, s32, s14
  s_lshl_b32 s22, s13, 4
  s_mul_i32 s16, s15, 1
  s_add_u32 s22, s22, s16
  v_and_b32 v8, 31, v12
  v_lshlrev_b32 v13, 3, v8
  v_lshlrev_b32 v9, 2, v8
  s_mov_b32 s10, 18415616
  s_mov_b32 s11, 0x00020000
  s_mul_i32 s16, s12, 81920
  s_lshl_b32 s23, s22, 10
  s_add_u32 s23, s23, s16
  s_lshl_b32 s30, s22, 8
  s_add_u32 s30, s30, s16
  s_add_u32 s30, s30, 65536
  s_lshl_b32 s31, s17, 13
  s_lshl_b32 s16, s22, 7
  s_add_u32 s31, s31, s16
  s_add_u32 s31, s31, 10649600
  s_mov_b32 s24, 0x000fffff
  s_mov_b32 s25, 0x000fffff
  s_mov_b32 s26, -1
  s_mov_b32 s27, 0
  s_mov_b32 s28, 0
  s_mov_b32 s29, -1
  v_mov_b32 v1, 0xdddddddd
  v_mov_b32 v15, 0
  s_mov_b32 s34, 0x01100000
  s_mov_b32 s35, 0x01100000
  s_mov_b64 exec, s[34:35]
  v_mov_b32 v15, 0x3f803f80
  s_mov_b64 exec, -1
  v_mov_b32 v84, v15
  v_mov_b32 v85, v15
  v_mov_b32 v86, v15
  v_mov_b32 v87, v15
  v_mov_b32 v88, v15
  v_mov_b32 v89, v15
  v_mov_b32 v90, v15
  v_mov_b32 v91, v15
  v_mov_b32 v76, 0x3f803f80
  v_mov_b32 v77, 0x3f80
  v_mov_b32 v78, 0x3f803f80
  v_mov_b32 v79, 0x3f80
  v_mov_b32 v92, v15
  v_mov_b32 v93, v15
  v_mov_b32 v94, v15
  v_mov_b32 v95, v15
  v_mov_b32 v96, v15
  v_mov_b32 v97, v15
  v_mov_b32 v98, v15
  v_mov_b32 v99, v15
  v_mov_b32 v80, 0x3f803f80
  v_mov_b32 v81, 0x3f80
  v_mov_b32 v82, 0x3f803f80
  v_mov_b32 v83, 0x3f80
  s_mov_b32 s19, 2
  s_mov_b32 s20, 0
  v_lshrrev_b32 v8, 5, v12
  v_mul_u32_u24 v8, 320, v8
  v_lshlrev_b32 v15, 1, v13
  v_add_u32 v14, v8, v15
  v_add_u32 v14, 10240, v14
  v_mov_b32 v100, 0
  v_mov_b32 v101, 0
  v_mov_b32 v2, v5
  v_add_u32 v3, 8192, v13
  v_mov_b32 v4, v14
  s_mov_b32 m0, s32
  s_waitcnt lgkmcnt(0)
  s_mov_b32 s8, s4
  s_mov_b32 s9, s5
  buffer_load_dwordx4 v5, s[8:11], s33 offen lds
  s_add_u32 s32, s32, 16384
  s_add_u32 s33, s33, 16384
  s_mov_b32 m0, s32
  s_nop 0
  buffer_load_dwordx4 v[64:67], v5, s[8:11], s23 offen offset:0
  s_mov_b64 exec, s[26:27]
  buffer_load_dwordx2 v[100:101], v13, s[8:11], s30 offen offset:0
  s_mov_b64 exec, -1
  buffer_load_dword v6, v9, s[8:11], s31 offen offset:0
  s_mul_i32 s21, s2, 16
  s_add_u32 s21, s21, s15
  s_mul_i32 s16, s21, 5243
  s_lshr_b32 s16, s16, 20
  s_mul_i32 s17, s16, 200
  s_sub_u32 s17, s21, s17
  s_mul_i32 s23, s17, 205
  s_lshr_b32 s23, s23, 10
  s_mul_i32 s30, s23, 5
  s_sub_u32 s17, s17, s30
  s_cmp_lt_u32 s23, 20
  s_cselect_b32 s36, s6, s38
  s_cselect_b32 s37, s7, s39
  s_cselect_b32 s30, 0, 20
  s_sub_u32 s23, s23, s30
  s_lshl_b32 s23, s23, 2
  s_cmp_lt_u32 s21, 1600
  s_cselect_b32 s38, 819200, 0
  s_mov_b32 s39, 0x00020000
  v_lshrrev_b32 v8, 4, v12
  v_add_u32 v8, s23, v8
  v_mul_u32_u24 v9, 205, v8
  v_lshrrev_b32 v9, 10, v9
  v_mul_u32_u24 v110, 5, v9
  v_sub_u32 v8, v8, v110
  v_mul_u32_u24 v110, 40, v9
  v_lshrrev_b32 v9, 1, v8
  v_mul_u32_u24 v9, 20, v9
  v_and_b32 v111, 1, v8
  v_lshl_add_u32 v9, v111, 3, v9
  v_cmp_eq_u32 vcc, 4, v8
  v_mov_b32 v111, 5120
  v_mov_b32 v8, 25600
  v_cndmask_b32 v9, v9, 16, vcc
  v_cndmask_b32 v111, v111, v8, vcc
  v_add_u32 v110, v110, v9
  v_mul_u32_u24 v110, 1280, v110
  v_and_b32 v8, 15, v12
  v_and_b32 v9, 12, v8
  s_cmp_lt_u32 s17, 4
  s_cselect_b32 s30, -1, 0
  v_and_b32 v9, s30, v9
  v_add_u32 v8, v8, v9
  s_lshr_b32 s30, s17, 1
  s_lshl_b32 s30, s30, 5
  s_and_b32 s17, s17, 1
  s_lshl_b32 s17, s17, 2
  s_add_u32 s30, s30, s17
  s_mul_i32 s16, s16, 80
  s_add_u32 s30, s30, s16
  s_lshl_b32 s34, s30, 1
  v_lshl_add_u32 v110, v8, 1, v110
  v_add_u32 v111, v111, v110
Lattn_zero:
  v_mov_b32 v48, 0
  v_mov_b32 v49, 0
  v_mov_b32 v50, 0
  v_mov_b32 v51, 0
  v_mov_b32 v52, 0
  v_mov_b32 v53, 0
  v_mov_b32 v54, 0
  v_mov_b32 v55, 0
  v_mov_b32 v56, 0
  v_mov_b32 v57, 0
  v_mov_b32 v58, 0
  v_mov_b32 v59, 0
  v_mov_b32 v60, 0
  v_mov_b32 v61, 0
  v_mov_b32 v62, 0
  v_mov_b32 v63, 0
  v_mov_b32 v40, 0
  v_mov_b32 v41, 0
  v_mov_b32 v42, 0
  v_mov_b32 v43, 0
  v_mov_b32 v44, 0
  v_mov_b32 v45, 0
  v_mov_b32 v46, 0
  v_mov_b32 v47, 0
  s_cmp_lg_u32 s20, 0
  s_cbranch_scc1 Lattn_start
  s_waitcnt vmcnt(3)
  s_barrier
Lattn_start:
  v_mov_b32 v2, v5
  v_add_u32 v3, 8192, v13
  v_mov_b32 v4, v14
  ds_read_b128 v[68:71], v2
  ds_read_b128 v[72:75], v2 offset:1024
  s_mov_b64 exec, s[26:27]
  ds_read2_b64 v[76:79], v3 offset0:0 offset1:32
  s_mov_b64 exec, s[24:25]
  ds_read_b128 v[84:87], v4
  ds_read_b128 v[88:91], v4 offset:640
  s_mov_b64 exec, -1
  s_waitcnt vmcnt(1) lgkmcnt(2)
Lattn_go:
  v_mfma_f32_32x32x8_bf16 v[16:31], v[76:77], v[100:101], 0
  v_mfma_f32_32x32x16_bf16 v[16:31], v[68:71], v[64:67], v[16:31]
  s_mov_b32 s18, 0
  s_cmp_lg_u32 s20, 0
  s_nop 9
  s_cbranch_scc1 Lattn_havemax
  v_max_f32 v10, v16, v17
  v_max3_f32 v10, v18, v19, v10
  v_max3_f32 v10, v20, v21, v10
  v_max3_f32 v10, v22, v23, v10
  v_max3_f32 v10, v24, v25, v10
  v_max3_f32 v10, v26, v27, v10
  v_max3_f32 v10, v28, v29, v10
  v_max3_f32 v10, v30, v31, v10
Lattn_havemax:
  v_mov_b32 v8, v10
  s_nop 1
  v_permlane32_swap_b32 v10, v8
  s_nop 1
  v_max_f32 v10, v10, v8
  v_xor_b32 v10, 0x80000000, v10
  s_mov_b64 exec, s[28:29]
  v_and_b32 v8, 0xffff0000, v10
  v_sub_f32 v9, v10, v8
  v_and_b32 v100, 0xffff0000, v9
  v_sub_f32 v9, v9, v100
  v_lshrrev_b32 v101, 16, v9
  v_lshrrev_b32 v8, 16, v8
  v_or_b32 v100, v100, v8
  s_mov_b64 exec, -1
  v_add_f32 v16, v16, v10
  v_add_f32 v17, v17, v10
  v_add_f32 v18, v18, v10
  v_add_f32 v19, v19, v10
  v_add_f32 v20, v20, v10
  v_add_f32 v21, v21, v10
  v_add_f32 v22, v22, v10
  v_add_f32 v23, v23, v10
  v_add_f32 v24, v24, v10
  v_add_f32 v25, v25, v10
  v_add_f32 v26, v26, v10
  v_add_f32 v27, v27, v10
  v_add_f32 v28, v28, v10
  v_add_f32 v29, v29, v10
  v_add_f32 v30, v30, v10
  v_add_f32 v31, v31, v10
  s_setprio 3
  s_cmp_lg_u32 s20, 0
  s_cbranch_scc1 Lattn_loop
Lattn_peel:
  v_exp_f32 v16, v16
  v_exp_f32 v17, v17
  v_smfmac_f32_32x32x32_bf16 v[48:63], v[96:99], v[40:47], v1
  v_exp_f32 v18, v18
  v_exp_f32 v19, v19
  buffer_load_dwordx4 v5, s[8:11], s33 offen lds
  s_add_u32 s32, s32, 16384
  s_add_u32 s33, s33, 16384
  s_mov_b32 m0, s32
  s_nop 0
  buffer_load_dwordx4 v5, s[8:11], s33 offen lds
  s_add_u32 s32, s32, 16384
  s_add_u32 s33, s33, 16384
  s_mov_b32 m0, s32
  s_nop 0
  v_exp_f32 v20, v20
  v_exp_f32 v21, v21
  s_waitcnt lgkmcnt(0)
  v_mfma_f32_32x32x8_bf16 v[32:47], v[78:79], v[100:101], 0
  v_exp_f32 v22, v22
  v_exp_f32 v23, v23
  v_exp_f32 v24, v24
  v_exp_f32 v25, v25
  v_mfma_f32_32x32x16_bf16 v[32:47], v[72:75], v[64:67], v[32:47]
  v_exp_f32 v26, v26
  v_exp_f32 v27, v27
  v_exp_f32 v28, v28
  v_exp_f32 v29, v29
  v_smfmac_f32_32x32x32_bf16 v[48:63], v[84:87], v[16:23], v1
  s_mov_b64 exec, s[24:25]
  ds_read_b128 v[92:95], v4 offset:1280
  ds_read_b128 v[96:99], v4 offset:1920
  s_mov_b64 exec, s[26:27]
  ds_read2_b64 v[80:83], v3 offset0:64 offset1:96
  s_mov_b64 exec, -1
  ds_read_b128 v[68:71], v2 offset:2048
  v_exp_f32 v30, v30
  v_exp_f32 v31, v31
  v_exp_f32 v32, v32
  v_exp_f32 v33, v33
  v_smfmac_f32_32x32x32_bf16 v[48:63], v[88:91], v[24:31], v1
  v_exp_f32 v34, v34
  v_exp_f32 v35, v35
  buffer_load_dwordx4 v5, s[8:11], s33 offen lds
  s_add_u32 s32, s32, 16384
  s_add_u32 s33, s33, 16384
  s_mov_b32 m0, s32
  s_nop 0
  v_exp_f32 v36, v36
  v_exp_f32 v37, v37
  s_waitcnt lgkmcnt(0)
  v_mfma_f32_32x32x8_bf16 v[16:31], v[80:81], v[100:101], 0
  v_exp_f32 v38, v38
  v_exp_f32 v39, v39
  v_exp_f32 v40, v40
  v_exp_f32 v41, v41
  v_mfma_f32_32x32x16_bf16 v[16:31], v[68:71], v[64:67], v[16:31]
  v_exp_f32 v42, v42
  v_exp_f32 v43, v43
  v_exp_f32 v44, v44
  v_exp_f32 v45, v45
  v_smfmac_f32_32x32x32_bf16 v[48:63], v[92:95], v[32:39], v1
  s_mov_b64 exec, s[24:25]
  ds_read_b128 v[84:87], v4 offset:2560
  ds_read_b128 v[88:91], v4 offset:3200
  s_mov_b64 exec, -1
  ds_read_b128 v[72:75], v2 offset:3072
  v_exp_f32 v46, v46
  v_exp_f32 v47, v47
  v_exp_f32 v16, v16
  v_exp_f32 v17, v17
  v_smfmac_f32_32x32x32_bf16 v[48:63], v[96:99], v[40:47], v1
  v_exp_f32 v18, v18
  v_exp_f32 v19, v19
  buffer_load_dwordx4 v5, s[8:11], s33 offen lds
  s_add_u32 s32, s32, 16384
  s_add_u32 s33, s33, 16384
  s_mov_b32 m0, s32
  s_nop 0
  v_exp_f32 v20, v20
  v_exp_f32 v21, v21
  s_waitcnt lgkmcnt(0)
  v_mfma_f32_32x32x8_bf16 v[32:47], v[82:83], v[100:101], 0
  v_exp_f32 v22, v22
  v_exp_f32 v23, v23
  v_exp_f32 v24, v24
  v_exp_f32 v25, v25
  v_mfma_f32_32x32x16_bf16 v[32:47], v[72:75], v[64:67], v[32:47]
  v_exp_f32 v26, v26
  v_exp_f32 v27, v27
  v_exp_f32 v28, v28
  v_exp_f32 v29, v29
  v_smfmac_f32_32x32x32_bf16 v[48:63], v[84:87], v[16:23], v1
  s_mov_b64 exec, s[24:25]
  ds_read_b128 v[92:95], v4 offset:3840
  ds_read_b128 v[96:99], v4 offset:4480
  s_mov_b64 exec, s[26:27]
  ds_read2_b64 v[76:79], v3 offset0:128 offset1:160
  s_mov_b64 exec, -1
  ds_read_b128 v[68:71], v2 offset:4096
  v_exp_f32 v30, v30
  v_exp_f32 v31, v31
  v_exp_f32 v32, v32
  v_exp_f32 v33, v33
  v_smfmac_f32_32x32x32_bf16 v[48:63], v[88:91], v[24:31], v1
  v_exp_f32 v34, v34
  v_exp_f32 v35, v35
  buffer_load_dwordx4 v5, s[8:11], s33 offen lds
  s_add_u32 s32, s32, 16384
  s_add_u32 s33, s33, 16384
  s_mov_b32 m0, s32
  s_nop 0
  v_exp_f32 v36, v36
  v_exp_f32 v37, v37
  s_waitcnt lgkmcnt(0)
  v_mfma_f32_32x32x8_bf16 v[16:31], v[76:77], v[100:101], 0
  v_exp_f32 v38, v38
  v_exp_f32 v39, v39
  v_exp_f32 v40, v40
  v_exp_f32 v41, v41
  v_mfma_f32_32x32x16_bf16 v[16:31], v[68:71], v[64:67], v[16:31]
  v_exp_f32 v42, v42
  v_exp_f32 v43, v43
  v_exp_f32 v44, v44
  v_exp_f32 v45, v45
  s_waitcnt vmcnt(3)
  s_barrier
  v_smfmac_f32_32x32x32_bf16 v[48:63], v[92:95], v[32:39], v1
  s_mov_b64 exec, s[24:25]
  ds_read_b128 v[84:87], v4 offset:5120
  ds_read_b128 v[88:91], v4 offset:5760
  s_mov_b64 exec, -1
  ds_read_b128 v[72:75], v2 offset:5120
  v_exp_f32 v46, v46
  v_exp_f32 v47, v47
  v_exp_f32 v16, v16
  v_exp_f32 v17, v17
  v_smfmac_f32_32x32x32_bf16 v[48:63], v[96:99], v[40:47], v1
  v_exp_f32 v18, v18
  v_exp_f32 v19, v19
  buffer_load_dwordx4 v5, s[8:11], s33 offen lds
  s_add_u32 s32, s32, 16384
  s_add_u32 s33, s33, 16384
  s_mov_b32 m0, s32
  s_nop 0
  v_exp_f32 v20, v20
  v_exp_f32 v21, v21
  s_waitcnt lgkmcnt(0)
  v_mfma_f32_32x32x8_bf16 v[32:47], v[78:79], v[100:101], 0
  v_exp_f32 v22, v22
  v_exp_f32 v23, v23
  v_exp_f32 v24, v24
  v_exp_f32 v25, v25
  v_mfma_f32_32x32x16_bf16 v[32:47], v[72:75], v[64:67], v[32:47]
  v_exp_f32 v26, v26
  v_exp_f32 v27, v27
  v_exp_f32 v28, v28
  v_exp_f32 v29, v29
  v_smfmac_f32_32x32x32_bf16 v[48:63], v[84:87], v[16:23], v1
  s_mov_b64 exec, s[24:25]
  ds_read_b128 v[92:95], v4 offset:6400
  ds_read_b128 v[96:99], v4 offset:7040
  s_mov_b64 exec, s[26:27]
  ds_read2_b64 v[80:83], v3 offset0:192 offset1:224
  s_mov_b64 exec, -1
  ds_read_b128 v[68:71], v2 offset:6144
  v_exp_f32 v30, v30
  v_exp_f32 v31, v31
  v_exp_f32 v32, v32
  v_exp_f32 v33, v33
  v_smfmac_f32_32x32x32_bf16 v[48:63], v[88:91], v[24:31], v1
  v_exp_f32 v34, v34
  v_exp_f32 v35, v35
  buffer_load_dwordx4 v5, s[8:11], s33 offen lds
  s_add_u32 s32, s32, 16384
  s_add_u32 s33, s33, 16384
  s_mov_b32 m0, s32
  s_nop 0
  v_exp_f32 v36, v36
  v_exp_f32 v37, v37
  s_waitcnt lgkmcnt(0)
  v_mfma_f32_32x32x8_bf16 v[16:31], v[80:81], v[100:101], 0
  v_exp_f32 v38, v38
  v_exp_f32 v39, v39
  v_exp_f32 v40, v40
  v_exp_f32 v41, v41
  v_mfma_f32_32x32x16_bf16 v[16:31], v[68:71], v[64:67], v[16:31]
  v_exp_f32 v42, v42
  v_exp_f32 v43, v43
  v_exp_f32 v44, v44
  v_exp_f32 v45, v45
  v_smfmac_f32_32x32x32_bf16 v[48:63], v[92:95], v[32:39], v1
  s_mov_b64 exec, s[24:25]
  ds_read_b128 v[84:87], v4 offset:7680
  ds_read_b128 v[88:91], v4 offset:8320
  s_mov_b64 exec, -1
  ds_read_b128 v[72:75], v2 offset:7168
  v_exp_f32 v46, v46
  v_exp_f32 v47, v47
  v_exp_f32 v16, v16
  v_exp_f32 v17, v17
  v_smfmac_f32_32x32x32_bf16 v[48:63], v[96:99], v[40:47], v1
  v_exp_f32 v18, v18
  v_exp_f32 v19, v19
  buffer_load_dwordx4 v5, s[8:11], s33 offen lds
  s_add_u32 s32, s32, 16384
  s_add_u32 s33, s33, 16384
  s_mov_b32 m0, s32
  s_nop 0
  v_exp_f32 v20, v20
  v_exp_f32 v21, v21
  s_waitcnt lgkmcnt(0)
  v_mfma_f32_32x32x8_bf16 v[32:47], v[82:83], v[100:101], 0
  v_exp_f32 v22, v22
  v_exp_f32 v23, v23
  v_exp_f32 v24, v24
  v_exp_f32 v25, v25
  v_mfma_f32_32x32x16_bf16 v[32:47], v[72:75], v[64:67], v[32:47]
  v_exp_f32 v26, v26
  v_exp_f32 v27, v27
  v_exp_f32 v28, v28
  v_exp_f32 v29, v29
  v_add_u32 v3, 20480, v3
  v_smfmac_f32_32x32x32_bf16 v[48:63], v[84:87], v[16:23], v1
  s_mov_b64 exec, s[24:25]
  ds_read_b128 v[92:95], v4 offset:8960
  ds_read_b128 v[96:99], v4 offset:9600
  s_mov_b64 exec, s[26:27]
  ds_read2_b64 v[76:79], v3 offset0:0 offset1:32
  s_mov_b64 exec, -1
  ds_read_b128 v[68:71], v2 offset:20480
  v_exp_f32 v30, v30
  v_exp_f32 v31, v31
  v_exp_f32 v32, v32
  v_exp_f32 v33, v33
  v_smfmac_f32_32x32x32_bf16 v[48:63], v[88:91], v[24:31], v1
  v_exp_f32 v34, v34
  v_exp_f32 v35, v35
  buffer_load_dwordx4 v5, s[8:11], s33 offen lds
  v_exp_f32 v36, v36
  v_exp_f32 v37, v37
  s_waitcnt lgkmcnt(0)
  v_mfma_f32_32x32x8_bf16 v[16:31], v[76:77], v[100:101], 0
  v_exp_f32 v38, v38
  v_exp_f32 v39, v39
  v_exp_f32 v40, v40
  v_exp_f32 v41, v41
  v_mfma_f32_32x32x16_bf16 v[16:31], v[68:71], v[64:67], v[16:31]
  v_exp_f32 v42, v42
  v_exp_f32 v43, v43
  v_exp_f32 v44, v44
  v_exp_f32 v45, v45
  v_smfmac_f32_32x32x32_bf16 v[48:63], v[92:95], v[32:39], v1
  s_mov_b64 exec, s[24:25]
  ds_read_b128 v[84:87], v4 offset:20480
  ds_read_b128 v[88:91], v4 offset:21120
  s_mov_b64 exec, -1
  ds_read_b128 v[72:75], v2 offset:21504
  v_exp_f32 v46, v46
  v_exp_f32 v47, v47
  v_add_u32 v2, 20480, v2
  v_add_u32 v4, 20480, v4
  buffer_load_ushort v102, v110, s[36:39], s34 offen offset:0
  buffer_load_ushort v103, v110, s[36:39], s34 offen offset:1280
  buffer_load_ushort v104, v110, s[36:39], s34 offen offset:2560
  buffer_load_ushort v105, v110, s[36:39], s34 offen offset:3840
  buffer_load_ushort v106, v111, s[36:39], s34 offen offset:0
  buffer_load_ushort v107, v111, s[36:39], s34 offen offset:1280
  buffer_load_ushort v108, v111, s[36:39], s34 offen offset:2560
  buffer_load_ushort v109, v111, s[36:39], s34 offen offset:3840
  v_exp_f32 v16, v16
  v_exp_f32 v17, v17
  v_smfmac_f32_32x32x32_bf16 v[48:63], v[96:99], v[40:47], v1
  v_exp_f32 v18, v18
  v_exp_f32 v19, v19
  v_exp_f32 v20, v20
  v_exp_f32 v21, v21
  s_waitcnt lgkmcnt(0)
  v_mfma_f32_32x32x8_bf16 v[32:47], v[78:79], v[100:101], 0
  v_exp_f32 v22, v22
  v_exp_f32 v23, v23
  v_exp_f32 v24, v24
  v_exp_f32 v25, v25
  v_mfma_f32_32x32x16_bf16 v[32:47], v[72:75], v[64:67], v[32:47]
  v_exp_f32 v26, v26
  v_exp_f32 v27, v27
  v_exp_f32 v28, v28
  v_exp_f32 v29, v29
  v_smfmac_f32_32x32x32_bf16 v[48:63], v[84:87], v[16:23], v1
  s_mov_b64 exec, s[24:25]
  ds_read_b128 v[92:95], v4 offset:1280
  ds_read_b128 v[96:99], v4 offset:1920
  s_mov_b64 exec, s[26:27]
  ds_read2_b64 v[80:83], v3 offset0:64 offset1:96
  s_mov_b64 exec, -1
  ds_read_b128 v[68:71], v2 offset:2048
  v_exp_f32 v30, v30
  v_exp_f32 v31, v31
  v_exp_f32 v32, v32
  v_exp_f32 v33, v33
  v_smfmac_f32_32x32x32_bf16 v[48:63], v[88:91], v[24:31], v1
  v_exp_f32 v34, v34
  v_exp_f32 v35, v35
  v_exp_f32 v36, v36
  v_exp_f32 v37, v37
  s_waitcnt lgkmcnt(0)
  v_mfma_f32_32x32x8_bf16 v[16:31], v[80:81], v[100:101], 0
  v_exp_f32 v38, v38
  v_exp_f32 v39, v39
  v_exp_f32 v40, v40
  v_exp_f32 v41, v41
  v_mfma_f32_32x32x16_bf16 v[16:31], v[68:71], v[64:67], v[16:31]
  v_exp_f32 v42, v42
  v_exp_f32 v43, v43
  v_exp_f32 v44, v44
  v_exp_f32 v45, v45
  v_smfmac_f32_32x32x32_bf16 v[48:63], v[92:95], v[32:39], v1
  s_mov_b64 exec, s[24:25]
  ds_read_b128 v[84:87], v4 offset:2560
  ds_read_b128 v[88:91], v4 offset:3200
  s_mov_b64 exec, -1
  ds_read_b128 v[72:75], v2 offset:3072
  v_exp_f32 v46, v46
  v_exp_f32 v47, v47
  v_exp_f32 v16, v16
  v_exp_f32 v17, v17
  v_smfmac_f32_32x32x32_bf16 v[48:63], v[96:99], v[40:47], v1
  v_exp_f32 v18, v18
  v_exp_f32 v19, v19
  v_exp_f32 v20, v20
  v_exp_f32 v21, v21
  s_waitcnt lgkmcnt(0)
  v_mfma_f32_32x32x8_bf16 v[32:47], v[82:83], v[100:101], 0
  v_exp_f32 v22, v22
  v_exp_f32 v23, v23
  v_exp_f32 v24, v24
  v_exp_f32 v25, v25
  v_mfma_f32_32x32x16_bf16 v[32:47], v[72:75], v[64:67], v[32:47]
  v_exp_f32 v26, v26
  v_exp_f32 v27, v27
  v_exp_f32 v28, v28
  v_exp_f32 v29, v29
  v_smfmac_f32_32x32x32_bf16 v[48:63], v[84:87], v[16:23], v1
  s_mov_b64 exec, s[24:25]
  ds_read_b128 v[92:95], v4 offset:3840
  ds_read_b128 v[96:99], v4 offset:4480
  s_mov_b64 exec, s[26:27]
  ds_read2_b64 v[76:79], v3 offset0:128 offset1:160
  s_mov_b64 exec, -1
  ds_read_b128 v[68:71], v2 offset:4096
  v_exp_f32 v30, v30
  v_exp_f32 v31, v31
  v_exp_f32 v32, v32
  v_exp_f32 v33, v33
  v_smfmac_f32_32x32x32_bf16 v[48:63], v[88:91], v[24:31], v1
  v_exp_f32 v34, v34
  v_exp_f32 v35, v35
  v_exp_f32 v36, v36
  v_exp_f32 v37, v37
  s_waitcnt lgkmcnt(0)
  v_mfma_f32_32x32x8_bf16 v[16:31], v[76:77], v[100:101], 0
  v_exp_f32 v38, v38
  v_exp_f32 v39, v39
  v_exp_f32 v40, v40
  v_exp_f32 v41, v41
  v_mfma_f32_32x32x16_bf16 v[16:31], v[68:71], v[64:67], v[16:31]
  v_exp_f32 v42, v42
  v_exp_f32 v43, v43
  v_exp_f32 v44, v44
  v_exp_f32 v45, v45
  v_smfmac_f32_32x32x32_bf16 v[48:63], v[92:95], v[32:39], v1
  s_mov_b64 exec, s[24:25]
  ds_read_b128 v[84:87], v4 offset:5120
  ds_read_b128 v[88:91], v4 offset:5760
  s_mov_b64 exec, -1
  ds_read_b128 v[72:75], v2 offset:5120
  v_exp_f32 v46, v46
  v_exp_f32 v47, v47
  v_exp_f32 v16, v16
  v_exp_f32 v17, v17
  v_smfmac_f32_32x32x32_bf16 v[48:63], v[96:99], v[40:47], v1
  v_exp_f32 v18, v18
  v_exp_f32 v19, v19
  v_exp_f32 v20, v20
  v_exp_f32 v21, v21
  s_waitcnt lgkmcnt(0)
  v_mfma_f32_32x32x8_bf16 v[32:47], v[78:79], v[100:101], 0
  v_exp_f32 v22, v22
  v_exp_f32 v23, v23
  v_exp_f32 v24, v24
  v_exp_f32 v25, v25
  v_mfma_f32_32x32x16_bf16 v[32:47], v[72:75], v[64:67], v[32:47]
  v_exp_f32 v26, v26
  v_exp_f32 v27, v27
  v_exp_f32 v28, v28
  v_exp_f32 v29, v29
  v_smfmac_f32_32x32x32_bf16 v[48:63], v[84:87], v[16:23], v1
  s_mov_b64 exec, s[24:25]
  ds_read_b128 v[92:95], v4 offset:6400
  ds_read_b128 v[96:99], v4 offset:7040
  s_mov_b64 exec, s[26:27]
  ds_read2_b64 v[80:83], v3 offset0:192 offset1:224
  s_mov_b64 exec, -1
  ds_read_b128 v[68:71], v2 offset:6144
  v_exp_f32 v30, v30
  v_exp_f32 v31, v31
  v_exp_f32 v32, v32
  v_exp_f32 v33, v33
  v_smfmac_f32_32x32x32_bf16 v[48:63], v[88:91], v[24:31], v1
  v_exp_f32 v34, v34
  v_exp_f32 v35, v35
  v_exp_f32 v36, v36
  v_exp_f32 v37, v37
  s_waitcnt lgkmcnt(0)
  v_mfma_f32_32x32x8_bf16 v[16:31], v[80:81], v[100:101], 0
  v_exp_f32 v38, v38
  v_exp_f32 v39, v39
  v_exp_f32 v40, v40
  v_exp_f32 v41, v41
  v_mfma_f32_32x32x16_bf16 v[16:31], v[68:71], v[64:67], v[16:31]
  v_exp_f32 v42, v42
  v_exp_f32 v43, v43
  v_exp_f32 v44, v44
  v_exp_f32 v45, v45
  v_smfmac_f32_32x32x32_bf16 v[48:63], v[92:95], v[32:39], v1
  s_mov_b64 exec, s[24:25]
  ds_read_b128 v[84:87], v4 offset:7680
  ds_read_b128 v[88:91], v4 offset:8320
  s_mov_b64 exec, -1
  ds_read_b128 v[72:75], v2 offset:7168
  v_exp_f32 v46, v46
  v_exp_f32 v47, v47
  v_exp_f32 v16, v16
  v_exp_f32 v17, v17
  v_smfmac_f32_32x32x32_bf16 v[48:63], v[96:99], v[40:47], v1
  v_exp_f32 v18, v18
  v_exp_f32 v19, v19
  v_exp_f32 v20, v20
  v_exp_f32 v21, v21
  s_waitcnt lgkmcnt(0)
  v_mfma_f32_32x32x8_bf16 v[32:47], v[82:83], v[100:101], 0
  v_exp_f32 v22, v22
  v_exp_f32 v23, v23
  v_exp_f32 v24, v24
  v_exp_f32 v25, v25
  v_mfma_f32_32x32x16_bf16 v[32:47], v[72:75], v[64:67], v[32:47]
  v_exp_f32 v26, v26
  v_exp_f32 v27, v27
  v_exp_f32 v28, v28
  v_exp_f32 v29, v29
  s_waitcnt vmcnt(0)
  s_barrier
  s_cmp_ge_u32 s21, 1600
  s_cbranch_scc1 Lattn_nowt
  s_lshl_b32 s16, s21, 10
  s_add_u32 s16, s16, 16777216
  v_lshl_or_b32 v102, v103, 16, v102
  v_lshl_or_b32 v103, v105, 16, v104
  v_lshl_or_b32 v104, v107, 16, v106
  v_lshl_or_b32 v105, v109, 16, v108
  buffer_store_dwordx4 v[102:105], v5, s[8:11], s16 offen sc0 sc1
Lattn_nowt:
  v_add_u32 v3, 20480, v3
  v_smfmac_f32_32x32x32_bf16 v[48:63], v[84:87], v[16:23], v1
  s_mov_b64 exec, s[24:25]
  ds_read_b128 v[92:95], v4 offset:8960
  ds_read_b128 v[96:99], v4 offset:9600
  s_mov_b64 exec, s[26:27]
  ds_read2_b64 v[76:79], v3 offset0:0 offset1:32
  s_mov_b64 exec, -1
  ds_read_b128 v[68:71], v2 offset:20480
  v_exp_f32 v30, v30
  v_exp_f32 v31, v31
  v_exp_f32 v32, v32
  v_exp_f32 v33, v33
  v_smfmac_f32_32x32x32_bf16 v[48:63], v[88:91], v[24:31], v1
  v_exp_f32 v34, v34
  v_exp_f32 v35, v35
  v_exp_f32 v36, v36
  v_exp_f32 v37, v37
  s_waitcnt lgkmcnt(0)
  v_mfma_f32_32x32x8_bf16 v[16:31], v[76:77], v[100:101], 0
  v_exp_f32 v38, v38
  v_exp_f32 v39, v39
  v_exp_f32 v40, v40
  v_exp_f32 v41, v41
  v_mfma_f32_32x32x16_bf16 v[16:31], v[68:71], v[64:67], v[16:31]
  v_exp_f32 v42, v42
  v_exp_f32 v43, v43
  v_exp_f32 v44, v44
  v_exp_f32 v45, v45
  v_smfmac_f32_32x32x32_bf16 v[48:63], v[92:95], v[32:39], v1
  s_mov_b64 exec, s[24:25]
  ds_read_b128 v[84:87], v4 offset:20480
  ds_read_b128 v[88:91], v4 offset:21120
  s_mov_b64 exec, -1
  ds_read_b128 v[72:75], v2 offset:21504
  v_exp_f32 v46, v46
  v_exp_f32 v47, v47
  v_add_u32 v2, 20480, v2
  v_add_u32 v4, 20480, v4
  s_mov_b32 s18, 2
  .p2align 6
Lattn_loop:
  v_exp_f32 v16, v16
  v_exp_f32 v17, v17
  v_smfmac_f32_32x32x32_bf16 v[48:63], v[96:99], v[40:47], v1
  v_exp_f32 v18, v18
  v_exp_f32 v19, v19
  v_exp_f32 v20, v20
  v_exp_f32 v21, v21
  s_waitcnt lgkmcnt(0)
  v_mfma_f32_32x32x8_bf16 v[32:47], v[78:79], v[100:101], 0
  v_exp_f32 v22, v22
  v_exp_f32 v23, v23
  v_exp_f32 v24, v24
  v_exp_f32 v25, v25
  v_mfma_f32_32x32x16_bf16 v[32:47], v[72:75], v[64:67], v[32:47]
  v_exp_f32 v26, v26
  v_exp_f32 v27, v27
  v_exp_f32 v28, v28
  v_exp_f32 v29, v29
  v_smfmac_f32_32x32x32_bf16 v[48:63], v[84:87], v[16:23], v1
  s_mov_b64 exec, s[24:25]
  ds_read_b128 v[92:95], v4 offset:1280
  ds_read_b128 v[96:99], v4 offset:1920
  s_mov_b64 exec, s[26:27]
  ds_read2_b64 v[80:83], v3 offset0:64 offset1:96
  s_mov_b64 exec, -1
  ds_read_b128 v[68:71], v2 offset:2048
  v_exp_f32 v30, v30
  v_exp_f32 v31, v31
  v_exp_f32 v32, v32
  v_exp_f32 v33, v33
  v_smfmac_f32_32x32x32_bf16 v[48:63], v[88:91], v[24:31], v1
  v_exp_f32 v34, v34
  v_exp_f32 v35, v35
  v_exp_f32 v36, v36
  v_exp_f32 v37, v37
  s_waitcnt lgkmcnt(0)
  v_mfma_f32_32x32x8_bf16 v[16:31], v[80:81], v[100:101], 0
  v_exp_f32 v38, v38
  v_exp_f32 v39, v39
  v_exp_f32 v40, v40
  v_exp_f32 v41, v41
  v_mfma_f32_32x32x16_bf16 v[16:31], v[68:71], v[64:67], v[16:31]
  v_exp_f32 v42, v42
  v_exp_f32 v43, v43
  v_exp_f32 v44, v44
  v_exp_f32 v45, v45
  v_smfmac_f32_32x32x32_bf16 v[48:63], v[92:95], v[32:39], v1
  s_mov_b64 exec, s[24:25]
  ds_read_b128 v[84:87], v4 offset:2560
  ds_read_b128 v[88:91], v4 offset:3200
  s_mov_b64 exec, -1
  ds_read_b128 v[72:75], v2 offset:3072
  v_exp_f32 v46, v46
  v_exp_f32 v47, v47
  v_exp_f32 v16, v16
  v_exp_f32 v17, v17
  v_smfmac_f32_32x32x32_bf16 v[48:63], v[96:99], v[40:47], v1
  v_exp_f32 v18, v18
  v_exp_f32 v19, v19
  v_exp_f32 v20, v20
  v_exp_f32 v21, v21
  s_waitcnt lgkmcnt(0)
  v_mfma_f32_32x32x8_bf16 v[32:47], v[82:83], v[100:101], 0
  v_exp_f32 v22, v22
  v_exp_f32 v23, v23
  v_exp_f32 v24, v24
  v_exp_f32 v25, v25
  v_mfma_f32_32x32x16_bf16 v[32:47], v[72:75], v[64:67], v[32:47]
  v_exp_f32 v26, v26
  v_exp_f32 v27, v27
  v_exp_f32 v28, v28
  v_exp_f32 v29, v29
  v_smfmac_f32_32x32x32_bf16 v[48:63], v[84:87], v[16:23], v1
  s_mov_b64 exec, s[24:25]
  ds_read_b128 v[92:95], v4 offset:3840
  ds_read_b128 v[96:99], v4 offset:4480
  s_mov_b64 exec, s[26:27]
  ds_read2_b64 v[76:79], v3 offset0:128 offset1:160
  s_mov_b64 exec, -1
  ds_read_b128 v[68:71], v2 offset:4096
  v_exp_f32 v30, v30
  v_exp_f32 v31, v31
  v_exp_f32 v32, v32
  v_exp_f32 v33, v33
  v_smfmac_f32_32x32x32_bf16 v[48:63], v[88:91], v[24:31], v1
  v_exp_f32 v34, v34
  v_exp_f32 v35, v35
  v_exp_f32 v36, v36
  v_exp_f32 v37, v37
  s_waitcnt lgkmcnt(0)
  v_mfma_f32_32x32x8_bf16 v[16:31], v[76:77], v[100:101], 0
  v_exp_f32 v38, v38
  v_exp_f32 v39, v39
  v_exp_f32 v40, v40
  v_exp_f32 v41, v41
  v_mfma_f32_32x32x16_bf16 v[16:31], v[68:71], v[64:67], v[16:31]
  v_exp_f32 v42, v42
  v_exp_f32 v43, v43
  v_exp_f32 v44, v44
  v_exp_f32 v45, v45
  v_smfmac_f32_32x32x32_bf16 v[48:63], v[92:95], v[32:39], v1
  s_mov_b64 exec, s[24:25]
  ds_read_b128 v[84:87], v4 offset:5120
  ds_read_b128 v[88:91], v4 offset:5760
  s_mov_b64 exec, -1
  ds_read_b128 v[72:75], v2 offset:5120
  v_exp_f32 v46, v46
  v_exp_f32 v47, v47
  v_exp_f32 v16, v16
  v_exp_f32 v17, v17
  v_smfmac_f32_32x32x32_bf16 v[48:63], v[96:99], v[40:47], v1
  v_exp_f32 v18, v18
  v_exp_f32 v19, v19
  v_exp_f32 v20, v20
  v_exp_f32 v21, v21
  s_waitcnt lgkmcnt(0)
  v_mfma_f32_32x32x8_bf16 v[32:47], v[78:79], v[100:101], 0
  v_exp_f32 v22, v22
  v_exp_f32 v23, v23
  v_exp_f32 v24, v24
  v_exp_f32 v25, v25
  v_mfma_f32_32x32x16_bf16 v[32:47], v[72:75], v[64:67], v[32:47]
  v_exp_f32 v26, v26
  v_exp_f32 v27, v27
  v_exp_f32 v28, v28
  v_exp_f32 v29, v29
  v_smfmac_f32_32x32x32_bf16 v[48:63], v[84:87], v[16:23], v1
  s_mov_b64 exec, s[24:25]
  ds_read_b128 v[92:95], v4 offset:6400
  ds_read_b128 v[96:99], v4 offset:7040
  s_mov_b64 exec, s[26:27]
  ds_read2_b64 v[80:83], v3 offset0:192 offset1:224
  s_mov_b64 exec, -1
  ds_read_b128 v[68:71], v2 offset:6144
  v_exp_f32 v30, v30
  v_exp_f32 v31, v31
  v_exp_f32 v32, v32
  v_exp_f32 v33, v33
  v_smfmac_f32_32x32x32_bf16 v[48:63], v[88:91], v[24:31], v1
  v_exp_f32 v34, v34
  v_exp_f32 v35, v35
  v_exp_f32 v36, v36
  v_exp_f32 v37, v37
  s_waitcnt lgkmcnt(0)
  v_mfma_f32_32x32x8_bf16 v[16:31], v[80:81], v[100:101], 0
  v_exp_f32 v38, v38
  v_exp_f32 v39, v39
  v_exp_f32 v40, v40
  v_exp_f32 v41, v41
  v_mfma_f32_32x32x16_bf16 v[16:31], v[68:71], v[64:67], v[16:31]
  v_exp_f32 v42, v42
  v_exp_f32 v43, v43
  v_exp_f32 v44, v44
  v_exp_f32 v45, v45
  v_smfmac_f32_32x32x32_bf16 v[48:63], v[92:95], v[32:39], v1
  s_mov_b64 exec, s[24:25]
  ds_read_b128 v[84:87], v4 offset:7680
  ds_read_b128 v[88:91], v4 offset:8320
  s_mov_b64 exec, -1
  ds_read_b128 v[72:75], v2 offset:7168
  v_exp_f32 v46, v46
  v_exp_f32 v47, v47
  v_exp_f32 v16, v16
  v_exp_f32 v17, v17
  v_smfmac_f32_32x32x32_bf16 v[48:63], v[96:99], v[40:47], v1
  v_exp_f32 v18, v18
  v_exp_f32 v19, v19
  v_exp_f32 v20, v20
  v_exp_f32 v21, v21
  s_waitcnt lgkmcnt(0)
  v_mfma_f32_32x32x8_bf16 v[32:47], v[82:83], v[100:101], 0
  v_exp_f32 v22, v22
  v_exp_f32 v23, v23
  v_exp_f32 v24, v24
  v_exp_f32 v25, v25
  v_mfma_f32_32x32x16_bf16 v[32:47], v[72:75], v[64:67], v[32:47]
  v_exp_f32 v26, v26
  v_exp_f32 v27, v27
  v_exp_f32 v28, v28
  v_exp_f32 v29, v29
  v_add_u32 v3, 20480, v3
  v_smfmac_f32_32x32x32_bf16 v[48:63], v[84:87], v[16:23], v1
  s_mov_b64 exec, s[24:25]
  ds_read_b128 v[92:95], v4 offset:8960
  ds_read_b128 v[96:99], v4 offset:9600
  s_mov_b64 exec, s[26:27]
  ds_read2_b64 v[76:79], v3 offset0:0 offset1:32
  s_mov_b64 exec, -1
  ds_read_b128 v[68:71], v2 offset:20480
  v_exp_f32 v30, v30
  v_exp_f32 v31, v31
  v_exp_f32 v32, v32
  v_exp_f32 v33, v33
  v_smfmac_f32_32x32x32_bf16 v[48:63], v[88:91], v[24:31], v1
  v_exp_f32 v34, v34
  v_exp_f32 v35, v35
  v_exp_f32 v36, v36
  v_exp_f32 v37, v37
  s_waitcnt lgkmcnt(0)
  v_mfma_f32_32x32x8_bf16 v[16:31], v[76:77], v[100:101], 0
  v_exp_f32 v38, v38
  v_exp_f32 v39, v39
  v_exp_f32 v40, v40
  v_exp_f32 v41, v41
  v_mfma_f32_32x32x16_bf16 v[16:31], v[68:71], v[64:67], v[16:31]
  v_exp_f32 v42, v42
  v_exp_f32 v43, v43
  v_exp_f32 v44, v44
  v_exp_f32 v45, v45
  v_smfmac_f32_32x32x32_bf16 v[48:63], v[92:95], v[32:39], v1
  s_mov_b64 exec, s[24:25]
  ds_read_b128 v[84:87], v4 offset:20480
  ds_read_b128 v[88:91], v4 offset:21120
  s_mov_b64 exec, -1
  ds_read_b128 v[72:75], v2 offset:21504
  v_exp_f32 v46, v46
  v_exp_f32 v47, v47
  v_add_u32 v2, 20480, v2
  v_add_u32 v4, 20480, v4
  s_add_u32 s18, s18, 1
  s_cmp_lt_u32 s18, 5
  s_cbranch_scc1 Lattn_loop
  s_setprio 2
  s_cmp_eq_u32 s18, 5
  s_cbranch_scc1 Lattn_loop
  s_setprio 1
  s_cmp_eq_u32 s18, 6
  s_cbranch_scc1 Lattn_loop
  s_setprio 0
  s_cmp_lg_u32 s18, 7
  s_cbranch_scc1 Lattn_nopf
  s_lshr_b32 s16, s2, 3
  s_mul_i32 s16, s16, 16
  s_add_u32 s16, s16, s15
  s_lshl_b32 s16, s16, 10
  s_and_b32 s17, s2, 1
  s_mul_i32 s17, s17, 819200
  s_add_u32 s16, s16, s17
  s_add_u32 s16, s16, 16777216
  buffer_load_dword v106, v5, s[8:11], s16 offen
  s_add_u32 s16, s16, 524288
  buffer_load_dword v107, v5, s[8:11], s16 offen
  s_add_u32 s16, s16, 524288
Lattn_nopf:
  s_cmp_lt_u32 s18, 8
  s_cbranch_scc1 Lattn_loop
Lattn_loopend:
  v_smfmac_f32_32x32x32_bf16 v[48:63], v[96:99], v[40:47], v1
  s_waitcnt lgkmcnt(0)
  s_lshr_b32 s16, s12, 1
  s_mul_i32 s16, s16, 2560
  s_mul_i32 s17, s22, 81920
  s_add_u32 s16, s16, s17
  s_add_u32 s16, s16, 11534336
  s_and_b32 s17, s12, 1
  s_lshl_b32 s23, s17, 10
  s_add_u32 s23, s23, s16
  s_lshl_b32 s17, s17, 3
  s_add_u32 s16, s16, s17
  s_add_u32 s16, s16, 2048
  v_mov_b32 v8, 0x5d800000
  s_mov_b64 s[30:31], -1
  s_nop 3
  s_mov_b64 exec, s[28:29]
  v_mov_b32 v60, v56
  s_mov_b64 exec, -1
  v_cmp_lt_f32 vcc, v60, v8
  s_nop 1
  s_and_b64 s[30:31], s[30:31], vcc
  s_cmp_eq_u64 s[30:31], -1
  s_cbranch_scc0 Lattn_fallback
Lattn_ok:
  v_rcp_f32 v8, v60
  s_nop 0
  v_mul_f32 v8, v8, v6
  v_mul_f32 v48, v48, v8
  v_mul_f32 v49, v49, v8
  v_mul_f32 v50, v50, v8
  v_mul_f32 v51, v51, v8
  v_mul_f32 v52, v52, v8
  v_mul_f32 v53, v53, v8
  v_mul_f32 v54, v54, v8
  v_mul_f32 v55, v55, v8
  v_mul_f32 v56, v56, v8
  v_mul_f32 v57, v57, v8
  v_mul_f32 v58, v58, v8
  v_mul_f32 v59, v59, v8
  v_cvt_pk_bf16_f32 v16, v48, v49
  v_cvt_pk_bf16_f32 v17, v50, v51
  v_cvt_pk_bf16_f32 v18, v52, v53
  v_cvt_pk_bf16_f32 v19, v54, v55
  v_cvt_pk_bf16_f32 v20, v56, v57
  v_cvt_pk_bf16_f32 v21, v58, v59
  buffer_store_dwordx4 v[16:19], v5, s[8:11], s23 offen sc0 sc1
  s_mov_b64 exec, s[26:27]
  buffer_store_dwordx2 v[20:21], v5, s[8:11], s16 offen sc0 sc1
  s_mov_b64 exec, -1
Lattn_end:
  s_endpgm
Lattn_fallback:
  s_cmp_lg_u32 s20, 0
  s_cbranch_scc1 Lattn_ok
  s_mov_b32 s20, 1
  s_mov_b64 exec, s[28:29]
  v_mov_b32 v100, 0
  v_mov_b32 v101, 0
  s_mov_b64 exec, -1
  v_mov_b32 v10, 0xff800000
  s_mov_b32 s16, 0
Lattn_mloop:
  s_lshr_b32 s23, s16, 3
  s_mul_i32 s23, s23, 20480
  s_and_b32 s17, s16, 7
  s_lshl_b32 s30, s17, 10
  s_add_u32 s30, s30, s23
  s_lshl_b32 s31, s17, 8
  s_add_u32 s31, s31, s23
  v_add_u32 v8, s30, v5
  v_add_u32 v9, s31, v13
  ds_read_b128 v[68:71], v8
  s_mov_b64 exec, s[26:27]
  ds_read_b64 v[76:77], v9 offset:8192
  s_mov_b64 exec, -1
  s_waitcnt lgkmcnt(0)
  v_mfma_f32_32x32x8_bf16 v[16:31], v[76:77], v[100:101], 0
  v_mfma_f32_32x32x16_bf16 v[16:31], v[68:71], v[64:67], v[16:31]
  s_nop 15
  v_max3_f32 v10, v16, v17, v10
  v_max3_f32 v10, v18, v19, v10
  v_max3_f32 v10, v20, v21, v10
  v_max3_f32 v10, v22, v23, v10
  v_max3_f32 v10, v24, v25, v10
  v_max3_f32 v10, v26, v27, v10
  v_max3_f32 v10, v28, v29, v10
  v_max3_f32 v10, v30, v31, v10
  s_add_u32 s16, s16, 1
  s_cmp_lt_u32 s16, 64
  s_cbranch_scc1 Lattn_mloop
  s_branch Lattn_zero
.globl out_kernel
.p2align 8
.type out_kernel,@function
out_kernel:
  s_cmp_ge_u32 s2, 256
  s_cbranch_scc1 Lout_end
  s_load_dwordx2 s[4:5], s[0:1], 88
  s_load_dwordx2 s[6:7], s[0:1], 72
  v_and_b32 v1, 63, v0
  v_lshrrev_b32 v4, 6, v0
  v_lshlrev_b32 v8, 4, v1
  v_readfirstlane_b32 s18, v4
  v_lshrrev_b32 v6, 4, v1
  v_and_b32 v7, 15, v1
  s_and_b32 s19, s2, 7
  s_lshr_b32 s20, s2, 3
  s_lshr_b32 s16, s19, 1
  s_lshl_b32 s16, s16, 3
  s_and_b32 s24, s20, 7
  s_add_u32 s16, s16, s24
  s_and_b32 s17, s19, 1
  s_lshl_b32 s17, s17, 2
  s_lshr_b32 s20, s20, 3
  s_add_u32 s17, s17, s20
  v_lshlrev_b32 v2, 9, v6
  v_lshl_add_u32 v2, v7, 4, v2
  s_mul_i32 s21, s16, 163840
  s_lshr_b32 s19, s18, 1
  s_mul_i32 s19, s19, 81920
  s_add_u32 s21, s21, s19
  s_and_b32 s19, s18, 1
  s_lshl_b32 s19, s19, 8
  s_add_u32 s21, s21, s19
  s_add_u32 s21, s21, 11534336
  s_add_u32 s24, s21, 4096
  s_mul_i32 s22, s17, 204800
  s_mul_i32 s23, s18, 5120
  s_add_u32 s22, s22, s23
  s_add_u32 s22, s22, 16777216
  s_add_u32 s25, s22, 4096
  s_mov_b32 s10, 18415616
  s_mov_b32 s11, 0x00020000
  s_mov_b32 s14, 2621440
  s_mov_b32 s15, 0x00020000
  s_mov_b32 m0, s23
  s_waitcnt lgkmcnt(0)
  s_mov_b32 s8, s4
  s_mov_b32 s9, s5
  s_mov_b32 s12, s6
  s_mov_b32 s13, s7
  s_add_u32 m0, s23, 0
  s_nop 0
  buffer_load_dwordx4 v8, s[8:11], s22 offen offset:0 lds
  buffer_load_dwordx4 v8, s[8:11], s22 offen offset:1024 lds
  buffer_load_dwordx4 v8, s[8:11], s22 offen offset:2048 lds
  buffer_load_dwordx4 v8, s[8:11], s22 offen offset:3072 lds
  s_add_u32 m0, s23, 4096
  s_nop 0
  buffer_load_dwordx4 v8, s[8:11], s25 offen lds
  s_add_u32 s22, s22, 20480
  s_add_u32 s25, s25, 20480
  buffer_load_dwordx4 v[76:79], v2, s[8:11], s21 offen offset:0
  buffer_load_dwordx4 v[80:83], v2, s[8:11], s21 offen offset:2048
  buffer_load_dwordx4 v[84:87], v2, s[8:11], s24 offen offset:0
  buffer_load_dwordx4 v[88:91], v2, s[8:11], s24 offen offset:2048
  s_add_u32 s21, s21, 8192
  s_add_u32 s24, s24, 8192
  s_add_u32 m0, s23, 20480
  s_nop 0
  buffer_load_dwordx4 v8, s[8:11], s22 offen offset:0 lds
  buffer_load_dwordx4 v8, s[8:11], s22 offen offset:1024 lds
  buffer_load_dwordx4 v8, s[8:11], s22 offen offset:2048 lds
  buffer_load_dwordx4 v8, s[8:11], s22 offen offset:3072 lds
  s_add_u32 m0, s23, 24576
  s_nop 0
  buffer_load_dwordx4 v8, s[8:11], s25 offen lds
  s_add_u32 s22, s22, 20480
  s_add_u32 s25, s25, 20480
  buffer_load_dwordx4 v[92:95], v2, s[8:11], s21 offen offset:0
  buffer_load_dwordx4 v[96:99], v2, s[8:11], s21 offen offset:2048
  buffer_load_dwordx4 v[100:103], v2, s[8:11], s24 offen offset:0
  buffer_load_dwordx4 v[104:107], v2, s[8:11], s24 offen offset:2048
  s_add_u32 s21, s21, 8192
  s_add_u32 s24, s24, 8192
  s_lshl_b32 s19, s16, 6
  s_lshl_b32 s20, s18, 4
  s_add_u32 s19, s19, s20
  s_mul_i32 s19, s19, 1280
  s_mul_i32 s20, s17, 160
  s_add_u32 s19, s19, s20
  v_mul_u32_u24 v9, 1280, v7
  v_lshl_add_u32 v5, v6, 3, v9
  v_lshl_add_u32 v9, v6, 4, v9
  v_add_u32 v4, 40960, v8
  s_waitcnt vmcnt(9)
  s_barrier
  ds_read_b128 v[36:39], v8 offset:0
  ds_read_b128 v[40:43], v8 offset:1024
  ds_read_b128 v[44:47], v8 offset:2048
  ds_read_b128 v[48:51], v8 offset:3072
  ds_read_b128 v[52:55], v8 offset:4096
  ds_read_b128 v[56:59], v8 offset:5120
  ds_read_b128 v[60:63], v8 offset:6144
  ds_read_b128 v[64:67], v8 offset:7168
  ds_read_b128 v[68:71], v8 offset:8192
  ds_read_b128 v[72:75], v8 offset:9216
  s_add_u32 m0, s23, 40960
  s_nop 0
  buffer_load_dwordx4 v8, s[8:11], s22 offen offset:0 lds
  buffer_load_dwordx4 v8, s[8:11], s22 offen offset:1024 lds
  buffer_load_dwordx4 v8, s[8:11], s22 offen offset:2048 lds
  s_waitcnt lgkmcnt(5)
  v_mfma_f32_16x16x32_bf16 v[16:19], v[36:39], v[76:79], 0
  v_mfma_f32_16x16x32_bf16 v[20:23], v[40:43], v[76:79], 0
  v_mfma_f32_16x16x32_bf16 v[24:27], v[44:47], v[76:79], 0
  v_mfma_f32_16x16x32_bf16 v[28:31], v[48:51], v[76:79], 0
  v_mfma_f32_16x16x32_bf16 v[32:35], v[52:55], v[76:79], 0
  ds_read_b128 v[36:39], v8 offset:10240
  ds_read_b128 v[40:43], v8 offset:11264
  ds_read_b128 v[44:47], v8 offset:12288
  ds_read_b128 v[48:51], v8 offset:13312
  ds_read_b128 v[52:55], v8 offset:14336
  buffer_load_dwordx4 v8, s[8:11], s22 offen offset:3072 lds
  s_add_u32 m0, s23, 45056
  s_nop 0
  buffer_load_dwordx4 v8, s[8:11], s25 offen lds
  s_add_u32 s22, s22, 20480
  s_add_u32 s25, s25, 20480
  s_waitcnt lgkmcnt(5)
  v_mfma_f32_16x16x32_bf16 v[16:19], v[56:59], v[80:83], v[16:19]
  v_mfma_f32_16x16x32_bf16 v[20:23], v[60:63], v[80:83], v[20:23]
  v_mfma_f32_16x16x32_bf16 v[24:27], v[64:67], v[80:83], v[24:27]
  v_mfma_f32_16x16x32_bf16 v[28:31], v[68:71], v[80:83], v[28:31]
  v_mfma_f32_16x16x32_bf16 v[32:35], v[72:75], v[80:83], v[32:35]
  ds_read_b128 v[56:59], v8 offset:15360
  ds_read_b128 v[60:63], v8 offset:16384
  ds_read_b128 v[64:67], v8 offset:17408
  ds_read_b128 v[68:71], v8 offset:18432
  ds_read_b128 v[72:75], v8 offset:19456
  buffer_load_dwordx4 v[108:111], v2, s[8:11], s21 offen offset:0
  buffer_load_dwordx4 v[112:115], v2, s[8:11], s21 offen offset:2048
  s_waitcnt lgkmcnt(5)
  v_mfma_f32_16x16x32_bf16 v[16:19], v[36:39], v[84:87], v[16:19]
  v_mfma_f32_16x16x32_bf16 v[20:23], v[40:43], v[84:87], v[20:23]
  v_mfma_f32_16x16x32_bf16 v[24:27], v[44:47], v[84:87], v[24:27]
  v_mfma_f32_16x16x32_bf16 v[28:31], v[48:51], v[84:87], v[28:31]
  v_mfma_f32_16x16x32_bf16 v[32:35], v[52:55], v[84:87], v[32:35]
  buffer_load_dwordx4 v[116:119], v2, s[8:11], s24 offen offset:0
  buffer_load_dwordx4 v[120:123], v2, s[8:11], s24 offen offset:2048
  s_add_u32 s21, s21, 8192
  s_add_u32 s24, s24, 8192
  s_waitcnt lgkmcnt(0)
  v_mfma_f32_16x16x32_bf16 v[16:19], v[56:59], v[88:91], v[16:19]
  v_mfma_f32_16x16x32_bf16 v[20:23], v[60:63], v[88:91], v[20:23]
  v_mfma_f32_16x16x32_bf16 v[24:27], v[64:67], v[88:91], v[24:27]
  v_mfma_f32_16x16x32_bf16 v[28:31], v[68:71], v[88:91], v[28:31]
  v_mfma_f32_16x16x32_bf16 v[32:35], v[72:75], v[88:91], v[32:35]
  s_waitcnt vmcnt(9)
  s_barrier
  ds_read_b128 v[36:39], v8 offset:20480
  ds_read_b128 v[40:43], v8 offset:21504
  ds_read_b128 v[44:47], v8 offset:22528
  ds_read_b128 v[48:51], v8 offset:23552
  ds_read_b128 v[52:55], v8 offset:24576
  ds_read_b128 v[56:59], v8 offset:25600
  ds_read_b128 v[60:63], v8 offset:26624
  ds_read_b128 v[64:67], v8 offset:27648
  ds_read_b128 v[68:71], v8 offset:28672
  ds_read_b128 v[72:75], v8 offset:29696
  s_add_u32 m0, s23, 0
  s_nop 0
  buffer_load_dwordx4 v8, s[8:11], s22 offen offset:0 lds
  buffer_load_dwordx4 v8, s[8:11], s22 offen offset:1024 lds
  buffer_load_dwordx4 v8, s[8:11], s22 offen offset:2048 lds
  s_waitcnt lgkmcnt(5)
  v_mfma_f32_16x16x32_bf16 v[16:19], v[36:39], v[92:95], v[16:19]
  v_mfma_f32_16x16x32_bf16 v[20:23], v[40:43], v[92:95], v[20:23]
  v_mfma_f32_16x16x32_bf16 v[24:27], v[44:47], v[92:95], v[24:27]
  v_mfma_f32_16x16x32_bf16 v[28:31], v[48:51], v[92:95], v[28:31]
  v_mfma_f32_16x16x32_bf16 v[32:35], v[52:55], v[92:95], v[32:35]
  ds_read_b128 v[36:39], v8 offset:30720
  ds_read_b128 v[40:43], v8 offset:31744
  ds_read_b128 v[44:47], v8 offset:32768
  ds_read_b128 v[48:51], v8 offset:33792
  ds_read_b128 v[52:55], v8 offset:34816
  buffer_load_dwordx4 v8, s[8:11], s22 offen offset:3072 lds
  s_add_u32 m0, s23, 4096
  s_nop 0
  buffer_load_dwordx4 v8, s[8:11], s25 offen lds
  s_add_u32 s22, s22, 20480
  s_add_u32 s25, s25, 20480
  s_waitcnt lgkmcnt(5)
  v_mfma_f32_16x16x32_bf16 v[16:19], v[56:59], v[96:99], v[16:19]
  v_mfma_f32_16x16x32_bf16 v[20:23], v[60:63], v[96:99], v[20:23]
  v_mfma_f32_16x16x32_bf16 v[24:27], v[64:67], v[96:99], v[24:27]
  v_mfma_f32_16x16x32_bf16 v[28:31], v[68:71], v[96:99], v[28:31]
  v_mfma_f32_16x16x32_bf16 v[32:35], v[72:75], v[96:99], v[32:35]
  ds_read_b128 v[56:59], v8 offset:35840
  ds_read_b128 v[60:63], v8 offset:36864
  ds_read_b128 v[64:67], v8 offset:37888
  ds_read_b128 v[68:71], v8 offset:38912
  ds_read_b128 v[72:75], v8 offset:39936
  buffer_load_dwordx4 v[76:79], v2, s[8:11], s21 offen offset:0
  buffer_load_dwordx4 v[80:83], v2, s[8:11], s21 offen offset:2048
  s_waitcnt lgkmcnt(5)
  v_mfma_f32_16x16x32_bf16 v[16:19], v[36:39], v[100:103], v[16:19]
  v_mfma_f32_16x16x32_bf16 v[20:23], v[40:43], v[100:103], v[20:23]
  v_mfma_f32_16x16x32_bf16 v[24:27], v[44:47], v[100:103], v[24:27]
  v_mfma_f32_16x16x32_bf16 v[28:31], v[48:51], v[100:103], v[28:31]
  v_mfma_f32_16x16x32_bf16 v[32:35], v[52:55], v[100:103], v[32:35]
  buffer_load_dwordx4 v[84:87], v2, s[8:11], s24 offen offset:0
  buffer_load_dwordx4 v[88:91], v2, s[8:11], s24 offen offset:2048
  s_add_u32 s21, s21, 8192
  s_add_u32 s24, s24, 8192
  s_waitcnt lgkmcnt(0)
  v_mfma_f32_16x16x32_bf16 v[16:19], v[56:59], v[104:107], v[16:19]
  v_mfma_f32_16x16x32_bf16 v[20:23], v[60:63], v[104:107], v[20:23]
  v_mfma_f32_16x16x32_bf16 v[24:27], v[64:67], v[104:107], v[24:27]
  v_mfma_f32_16x16x32_bf16 v[28:31], v[68:71], v[104:107], v[28:31]
  v_mfma_f32_16x16x32_bf16 v[32:35], v[72:75], v[104:107], v[32:35]
  s_waitcnt vmcnt(9)
  s_barrier
  ds_read_b128 v[36:39], v8 offset:40960
  ds_read_b128 v[40:43], v8 offset:41984
  ds_read_b128 v[44:47], v8 offset:43008
  ds_read_b128 v[48:51], v8 offset:44032
  ds_read_b128 v[52:55], v8 offset:45056
  ds_read_b128 v[56:59], v8 offset:46080
  ds_read_b128 v[60:63], v8 offset:47104
  ds_read_b128 v[64:67], v8 offset:48128
  ds_read_b128 v[68:71], v8 offset:49152
  ds_read_b128 v[72:75], v8 offset:50176
  s_add_u32 m0, s23, 20480
  s_nop 0
  buffer_load_dwordx4 v8, s[8:11], s22 offen offset:0 lds
  buffer_load_dwordx4 v8, s[8:11], s22 offen offset:1024 lds
  buffer_load_dwordx4 v8, s[8:11], s22 offen offset:2048 lds
  s_waitcnt lgkmcnt(5)
  v_mfma_f32_16x16x32_bf16 v[16:19], v[36:39], v[108:111], v[16:19]
  v_mfma_f32_16x16x32_bf16 v[20:23], v[40:43], v[108:111], v[20:23]
  v_mfma_f32_16x16x32_bf16 v[24:27], v[44:47], v[108:111], v[24:27]
  v_mfma_f32_16x16x32_bf16 v[28:31], v[48:51], v[108:111], v[28:31]
  v_mfma_f32_16x16x32_bf16 v[32:35], v[52:55], v[108:111], v[32:35]
  ds_read_b128 v[36:39], v8 offset:51200
  ds_read_b128 v[40:43], v8 offset:52224
  ds_read_b128 v[44:47], v8 offset:53248
  ds_read_b128 v[48:51], v8 offset:54272
  ds_read_b128 v[52:55], v8 offset:55296
  buffer_load_dwordx4 v8, s[8:11], s22 offen offset:3072 lds
  s_add_u32 m0, s23, 24576
  s_nop 0
  buffer_load_dwordx4 v8, s[8:11], s25 offen lds
  s_add_u32 s22, s22, 20480
  s_add_u32 s25, s25, 20480
  s_waitcnt lgkmcnt(5)
  v_mfma_f32_16x16x32_bf16 v[16:19], v[56:59], v[112:115], v[16:19]
  v_mfma_f32_16x16x32_bf16 v[20:23], v[60:63], v[112:115], v[20:23]
  v_mfma_f32_16x16x32_bf16 v[24:27], v[64:67], v[112:115], v[24:27]
  v_mfma_f32_16x16x32_bf16 v[28:31], v[68:71], v[112:115], v[28:31]
  v_mfma_f32_16x16x32_bf16 v[32:35], v[72:75], v[112:115], v[32:35]
  ds_read_b128 v[56:59], v8 offset:56320
  ds_read_b128 v[60:63], v8 offset:57344
  ds_read_b128 v[64:67], v8 offset:58368
  ds_read_b128 v[68:71], v8 offset:59392
  ds_read_b128 v[72:75], v8 offset:60416
  buffer_load_dwordx4 v[92:95], v2, s[8:11], s21 offen offset:0
  buffer_load_dwordx4 v[96:99], v2, s[8:11], s21 offen offset:2048
  s_waitcnt lgkmcnt(5)
  v_mfma_f32_16x16x32_bf16 v[16:19], v[36:39], v[116:119], v[16:19]
  v_mfma_f32_16x16x32_bf16 v[20:23], v[40:43], v[116:119], v[20:23]
  v_mfma_f32_16x16x32_bf16 v[24:27], v[44:47], v[116:119], v[24:27]
  v_mfma_f32_16x16x32_bf16 v[28:31], v[48:51], v[116:119], v[28:31]
  v_mfma_f32_16x16x32_bf16 v[32:35], v[52:55], v[116:119], v[32:35]
  buffer_load_dwordx4 v[100:103], v2, s[8:11], s24 offen offset:0
  buffer_load_dwordx4 v[104:107], v2, s[8:11], s24 offen offset:2048
  s_add_u32 s21, s21, 8192
  s_add_u32 s24, s24, 8192
  s_waitcnt lgkmcnt(0)
  v_mfma_f32_16x16x32_bf16 v[16:19], v[56:59], v[120:123], v[16:19]
  v_mfma_f32_16x16x32_bf16 v[20:23], v[60:63], v[120:123], v[20:23]
  v_mfma_f32_16x16x32_bf16 v[24:27], v[64:67], v[120:123], v[24:27]
  v_mfma_f32_16x16x32_bf16 v[28:31], v[68:71], v[120:123], v[28:31]
  v_mfma_f32_16x16x32_bf16 v[32:35], v[72:75], v[120:123], v[32:35]
  s_waitcnt vmcnt(9)
  s_barrier
  ds_read_b128 v[36:39], v8 offset:0
  ds_read_b128 v[40:43], v8 offset:1024
  ds_read_b128 v[44:47], v8 offset:2048
  ds_read_b128 v[48:51], v8 offset:3072
  ds_read_b128 v[52:55], v8 offset:4096
  ds_read_b128 v[56:59], v8 offset:5120
  ds_read_b128 v[60:63], v8 offset:6144
  ds_read_b128 v[64:67], v8 offset:7168
  ds_read_b128 v[68:71], v8 offset:8192
  ds_read_b128 v[72:75], v8 offset:9216
  s_add_u32 m0, s23, 40960
  s_nop 0
  buffer_load_dwordx4 v8, s[8:11], s22 offen offset:0 lds
  buffer_load_dwordx4 v8, s[8:11], s22 offen offset:1024 lds
  buffer_load_dwordx4 v8, s[8:11], s22 offen offset:2048 lds
  s_waitcnt lgkmcnt(5)
  v_mfma_f32_16x16x32_bf16 v[16:19], v[36:39], v[76:79], v[16:19]
  v_mfma_f32_16x16x32_bf16 v[20:23], v[40:43], v[76:79], v[20:23]
  v_mfma_f32_16x16x32_bf16 v[24:27], v[44:47], v[76:79], v[24:27]
  v_mfma_f32_16x16x32_bf16 v[28:31], v[48:51], v[76:79], v[28:31]
  v_mfma_f32_16x16x32_bf16 v[32:35], v[52:55], v[76:79], v[32:35]
  ds_read_b128 v[36:39], v8 offset:10240
  ds_read_b128 v[40:43], v8 offset:11264
  ds_read_b128 v[44:47], v8 offset:12288
  ds_read_b128 v[48:51], v8 offset:13312
  ds_read_b128 v[52:55], v8 offset:14336
  buffer_load_dwordx4 v8, s[8:11], s22 offen offset:3072 lds
  s_add_u32 m0, s23, 45056
  s_nop 0
  buffer_load_dwordx4 v8, s[8:11], s25 offen lds
  s_add_u32 s22, s22, 20480
  s_add_u32 s25, s25, 20480
  s_waitcnt lgkmcnt(5)
  v_mfma_f32_16x16x32_bf16 v[16:19], v[56:59], v[80:83], v[16:19]
  v_mfma_f32_16x16x32_bf16 v[20:23], v[60:63], v[80:83], v[20:23]
  v_mfma_f32_16x16x32_bf16 v[24:27], v[64:67], v[80:83], v[24:27]
  v_mfma_f32_16x16x32_bf16 v[28:31], v[68:71], v[80:83], v[28:31]
  v_mfma_f32_16x16x32_bf16 v[32:35], v[72:75], v[80:83], v[32:35]
  ds_read_b128 v[56:59], v8 offset:15360
  ds_read_b128 v[60:63], v8 offset:16384
  ds_read_b128 v[64:67], v8 offset:17408
  ds_read_b128 v[68:71], v8 offset:18432
  ds_read_b128 v[72:75], v8 offset:19456
  buffer_load_dwordx4 v[108:111], v2, s[8:11], s21 offen offset:0
  buffer_load_dwordx4 v[112:115], v2, s[8:11], s21 offen offset:2048
  s_waitcnt lgkmcnt(5)
  v_mfma_f32_16x16x32_bf16 v[16:19], v[36:39], v[84:87], v[16:19]
  v_mfma_f32_16x16x32_bf16 v[20:23], v[40:43], v[84:87], v[20:23]
  v_mfma_f32_16x16x32_bf16 v[24:27], v[44:47], v[84:87], v[24:27]
  v_mfma_f32_16x16x32_bf16 v[28:31], v[48:51], v[84:87], v[28:31]
  v_mfma_f32_16x16x32_bf16 v[32:35], v[52:55], v[84:87], v[32:35]
  buffer_load_dwordx4 v[116:119], v2, s[8:11], s24 offen offset:0
  buffer_load_dwordx4 v[120:123], v2, s[8:11], s24 offen offset:2048
  s_add_u32 s21, s21, 8192
  s_add_u32 s24, s24, 8192
  s_waitcnt lgkmcnt(0)
  v_mfma_f32_16x16x32_bf16 v[16:19], v[56:59], v[88:91], v[16:19]
  v_mfma_f32_16x16x32_bf16 v[20:23], v[60:63], v[88:91], v[20:23]
  v_mfma_f32_16x16x32_bf16 v[24:27], v[64:67], v[88:91], v[24:27]
  v_mfma_f32_16x16x32_bf16 v[28:31], v[68:71], v[88:91], v[28:31]
  v_mfma_f32_16x16x32_bf16 v[32:35], v[72:75], v[88:91], v[32:35]
  s_waitcnt vmcnt(9)
  s_barrier
  ds_read_b128 v[36:39], v8 offset:20480
  ds_read_b128 v[40:43], v8 offset:21504
  ds_read_b128 v[44:47], v8 offset:22528
  ds_read_b128 v[48:51], v8 offset:23552
  ds_read_b128 v[52:55], v8 offset:24576
  ds_read_b128 v[56:59], v8 offset:25600
  ds_read_b128 v[60:63], v8 offset:26624
  ds_read_b128 v[64:67], v8 offset:27648
  ds_read_b128 v[68:71], v8 offset:28672
  ds_read_b128 v[72:75], v8 offset:29696
  s_add_u32 m0, s23, 0
  s_nop 0
  buffer_load_dwordx4 v8, s[8:11], s22 offen offset:0 lds
  buffer_load_dwordx4 v8, s[8:11], s22 offen offset:1024 lds
  buffer_load_dwordx4 v8, s[8:11], s22 offen offset:2048 lds
  s_waitcnt lgkmcnt(5)
  v_mfma_f32_16x16x32_bf16 v[16:19], v[36:39], v[92:95], v[16:19]
  v_mfma_f32_16x16x32_bf16 v[20:23], v[40:43], v[92:95], v[20:23]
  v_mfma_f32_16x16x32_bf16 v[24:27], v[44:47], v[92:95], v[24:27]
  v_mfma_f32_16x16x32_bf16 v[28:31], v[48:51], v[92:95], v[28:31]
  v_mfma_f32_16x16x32_bf16 v[32:35], v[52:55], v[92:95], v[32:35]
  ds_read_b128 v[36:39], v8 offset:30720
  ds_read_b128 v[40:43], v8 offset:31744
  ds_read_b128 v[44:47], v8 offset:32768
  ds_read_b128 v[48:51], v8 offset:33792
  ds_read_b128 v[52:55], v8 offset:34816
  buffer_load_dwordx4 v8, s[8:11], s22 offen offset:3072 lds
  s_add_u32 m0, s23, 4096
  s_nop 0
  buffer_load_dwordx4 v8, s[8:11], s25 offen lds
  s_add_u32 s22, s22, 20480
  s_add_u32 s25, s25, 20480
  s_waitcnt lgkmcnt(5)
  v_mfma_f32_16x16x32_bf16 v[16:19], v[56:59], v[96:99], v[16:19]
  v_mfma_f32_16x16x32_bf16 v[20:23], v[60:63], v[96:99], v[20:23]
  v_mfma_f32_16x16x32_bf16 v[24:27], v[64:67], v[96:99], v[24:27]
  v_mfma_f32_16x16x32_bf16 v[28:31], v[68:71], v[96:99], v[28:31]
  v_mfma_f32_16x16x32_bf16 v[32:35], v[72:75], v[96:99], v[32:35]
  ds_read_b128 v[56:59], v8 offset:35840
  ds_read_b128 v[60:63], v8 offset:36864
  ds_read_b128 v[64:67], v8 offset:37888
  ds_read_b128 v[68:71], v8 offset:38912
  ds_read_b128 v[72:75], v8 offset:39936
  buffer_load_dwordx4 v[76:79], v2, s[8:11], s21 offen offset:0
  buffer_load_dwordx4 v[80:83], v2, s[8:11], s21 offen offset:2048
  s_waitcnt lgkmcnt(5)
  v_mfma_f32_16x16x32_bf16 v[16:19], v[36:39], v[100:103], v[16:19]
  v_mfma_f32_16x16x32_bf16 v[20:23], v[40:43], v[100:103], v[20:23]
  v_mfma_f32_16x16x32_bf16 v[24:27], v[44:47], v[100:103], v[24:27]
  v_mfma_f32_16x16x32_bf16 v[28:31], v[48:51], v[100:103], v[28:31]
  v_mfma_f32_16x16x32_bf16 v[32:35], v[52:55], v[100:103], v[32:35]
  buffer_load_dwordx4 v[84:87], v2, s[8:11], s24 offen offset:0
  buffer_load_dwordx4 v[88:91], v2, s[8:11], s24 offen offset:2048
  s_add_u32 s21, s21, 8192
  s_add_u32 s24, s24, 8192
  s_waitcnt lgkmcnt(0)
  v_mfma_f32_16x16x32_bf16 v[16:19], v[56:59], v[104:107], v[16:19]
  v_mfma_f32_16x16x32_bf16 v[20:23], v[60:63], v[104:107], v[20:23]
  v_mfma_f32_16x16x32_bf16 v[24:27], v[64:67], v[104:107], v[24:27]
  v_mfma_f32_16x16x32_bf16 v[28:31], v[68:71], v[104:107], v[28:31]
  v_mfma_f32_16x16x32_bf16 v[32:35], v[72:75], v[104:107], v[32:35]
  s_waitcnt vmcnt(9)
  s_barrier
  ds_read_b128 v[36:39], v8 offset:40960
  ds_read_b128 v[40:43], v8 offset:41984
  ds_read_b128 v[44:47], v8 offset:43008
  ds_read_b128 v[48:51], v8 offset:44032
  ds_read_b128 v[52:55], v8 offset:45056
  ds_read_b128 v[56:59], v8 offset:46080
  ds_read_b128 v[60:63], v8 offset:47104
  ds_read_b128 v[64:67], v8 offset:48128
  ds_read_b128 v[68:71], v8 offset:49152
  ds_read_b128 v[72:75], v8 offset:50176
  s_add_u32 m0, s23, 20480
  s_nop 0
  buffer_load_dwordx4 v8, s[8:11], s22 offen offset:0 lds
  buffer_load_dwordx4 v8, s[8:11], s22 offen offset:1024 lds
  buffer_load_dwordx4 v8, s[8:11], s22 offen offset:2048 lds
  s_waitcnt lgkmcnt(5)
  v_mfma_f32_16x16x32_bf16 v[16:19], v[36:39], v[108:111], v[16:19]
  v_mfma_f32_16x16x32_bf16 v[20:23], v[40:43], v[108:111], v[20:23]
  v_mfma_f32_16x16x32_bf16 v[24:27], v[44:47], v[108:111], v[24:27]
  v_mfma_f32_16x16x32_bf16 v[28:31], v[48:51], v[108:111], v[28:31]
  v_mfma_f32_16x16x32_bf16 v[32:35], v[52:55], v[108:111], v[32:35]
  ds_read_b128 v[36:39], v8 offset:51200
  ds_read_b128 v[40:43], v8 offset:52224
  ds_read_b128 v[44:47], v8 offset:53248
  ds_read_b128 v[48:51], v8 offset:54272
  ds_read_b128 v[52:55], v8 offset:55296
  buffer_load_dwordx4 v8, s[8:11], s22 offen offset:3072 lds
  s_add_u32 m0, s23, 24576
  s_nop 0
  buffer_load_dwordx4 v8, s[8:11], s25 offen lds
  s_add_u32 s22, s22, 20480
  s_add_u32 s25, s25, 20480
  s_waitcnt lgkmcnt(5)
  v_mfma_f32_16x16x32_bf16 v[16:19], v[56:59], v[112:115], v[16:19]
  v_mfma_f32_16x16x32_bf16 v[20:23], v[60:63], v[112:115], v[20:23]
  v_mfma_f32_16x16x32_bf16 v[24:27], v[64:67], v[112:115], v[24:27]
  v_mfma_f32_16x16x32_bf16 v[28:31], v[68:71], v[112:115], v[28:31]
  v_mfma_f32_16x16x32_bf16 v[32:35], v[72:75], v[112:115], v[32:35]
  ds_read_b128 v[56:59], v8 offset:56320
  ds_read_b128 v[60:63], v8 offset:57344
  ds_read_b128 v[64:67], v8 offset:58368
  ds_read_b128 v[68:71], v8 offset:59392
  ds_read_b128 v[72:75], v8 offset:60416
  buffer_load_dwordx4 v[92:95], v2, s[8:11], s21 offen offset:0
  buffer_load_dwordx4 v[96:99], v2, s[8:11], s21 offen offset:2048
  s_waitcnt lgkmcnt(5)
  v_mfma_f32_16x16x32_bf16 v[16:19], v[36:39], v[116:119], v[16:19]
  v_mfma_f32_16x16x32_bf16 v[20:23], v[40:43], v[116:119], v[20:23]
  v_mfma_f32_16x16x32_bf16 v[24:27], v[44:47], v[116:119], v[24:27]
  v_mfma_f32_16x16x32_bf16 v[28:31], v[48:51], v[116:119], v[28:31]
  v_mfma_f32_16x16x32_bf16 v[32:35], v[52:55], v[116:119], v[32:35]
  buffer_load_dwordx4 v[100:103], v2, s[8:11], s24 offen offset:0
  buffer_load_dwordx4 v[104:107], v2, s[8:11], s24 offen offset:2048
  s_add_u32 s21, s21, 8192
  s_add_u32 s24, s24, 8192
  s_waitcnt lgkmcnt(0)
  v_mfma_f32_16x16x32_bf16 v[16:19], v[56:59], v[120:123], v[16:19]
  v_mfma_f32_16x16x32_bf16 v[20:23], v[60:63], v[120:123], v[20:23]
  v_mfma_f32_16x16x32_bf16 v[24:27], v[64:67], v[120:123], v[24:27]
  v_mfma_f32_16x16x32_bf16 v[28:31], v[68:71], v[120:123], v[28:31]
  v_mfma_f32_16x16x32_bf16 v[32:35], v[72:75], v[120:123], v[32:35]
  s_waitcnt vmcnt(9)
  s_barrier
  ds_read_b128 v[36:39], v8 offset:0
  ds_read_b128 v[40:43], v8 offset:1024
  ds_read_b128 v[44:47], v8 offset:2048
  ds_read_b128 v[48:51], v8 offset:3072
  ds_read_b128 v[52:55], v8 offset:4096
  ds_read_b128 v[56:59], v8 offset:5120
  ds_read_b128 v[60:63], v8 offset:6144
  ds_read_b128 v[64:67], v8 offset:7168
  ds_read_b128 v[68:71], v8 offset:8192
  ds_read_b128 v[72:75], v8 offset:9216
  s_add_u32 m0, s23, 40960
  s_nop 0
  buffer_load_dwordx4 v8, s[8:11], s22 offen offset:0 lds
  buffer_load_dwordx4 v8, s[8:11], s22 offen offset:1024 lds
  buffer_load_dwordx4 v8, s[8:11], s22 offen offset:2048 lds
  s_waitcnt lgkmcnt(5)
  v_mfma_f32_16x16x32_bf16 v[16:19], v[36:39], v[76:79], v[16:19]
  v_mfma_f32_16x16x32_bf16 v[20:23], v[40:43], v[76:79], v[20:23]
  v_mfma_f32_16x16x32_bf16 v[24:27], v[44:47], v[76:79], v[24:27]
  v_mfma_f32_16x16x32_bf16 v[28:31], v[48:51], v[76:79], v[28:31]
  v_mfma_f32_16x16x32_bf16 v[32:35], v[52:55], v[76:79], v[32:35]
  ds_read_b128 v[36:39], v8 offset:10240
  ds_read_b128 v[40:43], v8 offset:11264
  ds_read_b128 v[44:47], v8 offset:12288
  ds_read_b128 v[48:51], v8 offset:13312
  ds_read_b128 v[52:55], v8 offset:14336
  buffer_load_dwordx4 v8, s[8:11], s22 offen offset:3072 lds
  s_add_u32 m0, s23, 45056
  s_nop 0
  buffer_load_dwordx4 v8, s[8:11], s25 offen lds
  s_add_u32 s22, s22, 20480
  s_add_u32 s25, s25, 20480
  s_waitcnt lgkmcnt(5)
  v_mfma_f32_16x16x32_bf16 v[16:19], v[56:59], v[80:83], v[16:19]
  v_mfma_f32_16x16x32_bf16 v[20:23], v[60:63], v[80:83], v[20:23]
  v_mfma_f32_16x16x32_bf16 v[24:27], v[64:67], v[80:83], v[24:27]
  v_mfma_f32_16x16x32_bf16 v[28:31], v[68:71], v[80:83], v[28:31]
  v_mfma_f32_16x16x32_bf16 v[32:35], v[72:75], v[80:83], v[32:35]
  ds_read_b128 v[56:59], v8 offset:15360
  ds_read_b128 v[60:63], v8 offset:16384
  ds_read_b128 v[64:67], v8 offset:17408
  ds_read_b128 v[68:71], v8 offset:18432
  ds_read_b128 v[72:75], v8 offset:19456
  buffer_load_dwordx4 v[108:111], v2, s[8:11], s21 offen offset:0
  buffer_load_dwordx4 v[112:115], v2, s[8:11], s21 offen offset:2048
  s_waitcnt lgkmcnt(5)
  v_mfma_f32_16x16x32_bf16 v[16:19], v[36:39], v[84:87], v[16:19]
  v_mfma_f32_16x16x32_bf16 v[20:23], v[40:43], v[84:87], v[20:23]
  v_mfma_f32_16x16x32_bf16 v[24:27], v[44:47], v[84:87], v[24:27]
  v_mfma_f32_16x16x32_bf16 v[28:31], v[48:51], v[84:87], v[28:31]
  v_mfma_f32_16x16x32_bf16 v[32:35], v[52:55], v[84:87], v[32:35]
  buffer_load_dwordx4 v[116:119], v2, s[8:11], s24 offen offset:0
  buffer_load_dwordx4 v[120:123], v2, s[8:11], s24 offen offset:2048
  s_add_u32 s21, s21, 8192
  s_add_u32 s24, s24, 8192
  s_waitcnt lgkmcnt(0)
  v_mfma_f32_16x16x32_bf16 v[16:19], v[56:59], v[88:91], v[16:19]
  v_mfma_f32_16x16x32_bf16 v[20:23], v[60:63], v[88:91], v[20:23]
  v_mfma_f32_16x16x32_bf16 v[24:27], v[64:67], v[88:91], v[24:27]
  v_mfma_f32_16x16x32_bf16 v[28:31], v[68:71], v[88:91], v[28:31]
  v_mfma_f32_16x16x32_bf16 v[32:35], v[72:75], v[88:91], v[32:35]
  s_waitcnt vmcnt(9)
  s_barrier
  ds_read_b128 v[36:39], v8 offset:20480
  ds_read_b128 v[40:43], v8 offset:21504
  ds_read_b128 v[44:47], v8 offset:22528
  ds_read_b128 v[48:51], v8 offset:23552
  ds_read_b128 v[52:55], v8 offset:24576
  ds_read_b128 v[56:59], v8 offset:25600
  ds_read_b128 v[60:63], v8 offset:26624
  ds_read_b128 v[64:67], v8 offset:27648
  ds_read_b128 v[68:71], v8 offset:28672
  ds_read_b128 v[72:75], v8 offset:29696
  s_add_u32 m0, s23, 0
  s_nop 0
  buffer_load_dwordx4 v8, s[8:11], s22 offen offset:0 lds
  buffer_load_dwordx4 v8, s[8:11], s22 offen offset:1024 lds
  buffer_load_dwordx4 v8, s[8:11], s22 offen offset:2048 lds
  s_waitcnt lgkmcnt(5)
  v_mfma_f32_16x16x32_bf16 v[16:19], v[36:39], v[92:95], v[16:19]
  v_mfma_f32_16x16x32_bf16 v[20:23], v[40:43], v[92:95], v[20:23]
  v_mfma_f32_16x16x32_bf16 v[24:27], v[44:47], v[92:95], v[24:27]
  v_mfma_f32_16x16x32_bf16 v[28:31], v[48:51], v[92:95], v[28:31]
  v_mfma_f32_16x16x32_bf16 v[32:35], v[52:55], v[92:95], v[32:35]
  ds_read_b128 v[36:39], v8 offset:30720
  ds_read_b128 v[40:43], v8 offset:31744
  ds_read_b128 v[44:47], v8 offset:32768
  ds_read_b128 v[48:51], v8 offset:33792
  ds_read_b128 v[52:55], v8 offset:34816
  buffer_load_dwordx4 v8, s[8:11], s22 offen offset:3072 lds
  s_add_u32 m0, s23, 4096
  s_nop 0
  buffer_load_dwordx4 v8, s[8:11], s25 offen lds
  s_add_u32 s22, s22, 20480
  s_add_u32 s25, s25, 20480
  s_waitcnt lgkmcnt(5)
  v_mfma_f32_16x16x32_bf16 v[16:19], v[56:59], v[96:99], v[16:19]
  v_mfma_f32_16x16x32_bf16 v[20:23], v[60:63], v[96:99], v[20:23]
  v_mfma_f32_16x16x32_bf16 v[24:27], v[64:67], v[96:99], v[24:27]
  v_mfma_f32_16x16x32_bf16 v[28:31], v[68:71], v[96:99], v[28:31]
  v_mfma_f32_16x16x32_bf16 v[32:35], v[72:75], v[96:99], v[32:35]
  ds_read_b128 v[56:59], v8 offset:35840
  ds_read_b128 v[60:63], v8 offset:36864
  ds_read_b128 v[64:67], v8 offset:37888
  ds_read_b128 v[68:71], v8 offset:38912
  ds_read_b128 v[72:75], v8 offset:39936
  buffer_load_dwordx4 v[76:79], v2, s[8:11], s21 offen offset:0
  buffer_load_dwordx4 v[80:83], v2, s[8:11], s21 offen offset:2048
  s_waitcnt lgkmcnt(5)
  v_mfma_f32_16x16x32_bf16 v[16:19], v[36:39], v[100:103], v[16:19]
  v_mfma_f32_16x16x32_bf16 v[20:23], v[40:43], v[100:103], v[20:23]
  v_mfma_f32_16x16x32_bf16 v[24:27], v[44:47], v[100:103], v[24:27]
  v_mfma_f32_16x16x32_bf16 v[28:31], v[48:51], v[100:103], v[28:31]
  v_mfma_f32_16x16x32_bf16 v[32:35], v[52:55], v[100:103], v[32:35]
  buffer_load_dwordx4 v[84:87], v2, s[8:11], s24 offen offset:0
  buffer_load_dwordx4 v[88:91], v2, s[8:11], s24 offen offset:2048
  s_add_u32 s21, s21, 8192
  s_add_u32 s24, s24, 8192
  s_waitcnt lgkmcnt(0)
  v_mfma_f32_16x16x32_bf16 v[16:19], v[56:59], v[104:107], v[16:19]
  v_mfma_f32_16x16x32_bf16 v[20:23], v[60:63], v[104:107], v[20:23]
  v_mfma_f32_16x16x32_bf16 v[24:27], v[64:67], v[104:107], v[24:27]
  v_mfma_f32_16x16x32_bf16 v[28:31], v[68:71], v[104:107], v[28:31]
  v_mfma_f32_16x16x32_bf16 v[32:35], v[72:75], v[104:107], v[32:35]
  s_waitcnt vmcnt(9)
  s_barrier
  ds_read_b128 v[36:39], v8 offset:40960
  ds_read_b128 v[40:43], v8 offset:41984
  ds_read_b128 v[44:47], v8 offset:43008
  ds_read_b128 v[48:51], v8 offset:44032
  ds_read_b128 v[52:55], v8 offset:45056
  ds_read_b128 v[56:59], v8 offset:46080
  ds_read_b128 v[60:63], v8 offset:47104
  ds_read_b128 v[64:67], v8 offset:48128
  ds_read_b128 v[68:71], v8 offset:49152
  ds_read_b128 v[72:75], v8 offset:50176
  s_waitcnt lgkmcnt(5)
  v_mfma_f32_16x16x32_bf16 v[16:19], v[36:39], v[108:111], v[16:19]
  v_mfma_f32_16x16x32_bf16 v[20:23], v[40:43], v[108:111], v[20:23]
  v_mfma_f32_16x16x32_bf16 v[24:27], v[44:47], v[108:111], v[24:27]
  v_mfma_f32_16x16x32_bf16 v[28:31], v[48:51], v[108:111], v[28:31]
  v_mfma_f32_16x16x32_bf16 v[32:35], v[52:55], v[108:111], v[32:35]
  ds_read_b128 v[36:39], v8 offset:51200
  ds_read_b128 v[40:43], v8 offset:52224
  ds_read_b128 v[44:47], v8 offset:53248
  ds_read_b128 v[48:51], v8 offset:54272
  ds_read_b128 v[52:55], v8 offset:55296
  s_waitcnt lgkmcnt(5)
  v_mfma_f32_16x16x32_bf16 v[16:19], v[56:59], v[112:115], v[16:19]
  v_mfma_f32_16x16x32_bf16 v[20:23], v[60:63], v[112:115], v[20:23]
  v_mfma_f32_16x16x32_bf16 v[24:27], v[64:67], v[112:115], v[24:27]
  v_mfma_f32_16x16x32_bf16 v[28:31], v[68:71], v[112:115], v[28:31]
  v_mfma_f32_16x16x32_bf16 v[32:35], v[72:75], v[112:115], v[32:35]
  ds_read_b128 v[56:59], v8 offset:56320
  ds_read_b128 v[60:63], v8 offset:57344
  ds_read_b128 v[64:67], v8 offset:58368
  ds_read_b128 v[68:71], v8 offset:59392
  ds_read_b128 v[72:75], v8 offset:60416
  s_waitcnt lgkmcnt(5)
  v_mfma_f32_16x16x32_bf16 v[16:19], v[36:39], v[116:119], v[16:19]
  v_mfma_f32_16x16x32_bf16 v[20:23], v[40:43], v[116:119], v[20:23]
  v_mfma_f32_16x16x32_bf16 v[24:27], v[44:47], v[116:119], v[24:27]
  v_mfma_f32_16x16x32_bf16 v[28:31], v[48:51], v[116:119], v[28:31]
  v_mfma_f32_16x16x32_bf16 v[32:35], v[52:55], v[116:119], v[32:35]
  s_waitcnt lgkmcnt(0)
  v_mfma_f32_16x16x32_bf16 v[16:19], v[56:59], v[120:123], v[16:19]
  v_mfma_f32_16x16x32_bf16 v[20:23], v[60:63], v[120:123], v[20:23]
  v_mfma_f32_16x16x32_bf16 v[24:27], v[64:67], v[120:123], v[24:27]
  v_mfma_f32_16x16x32_bf16 v[28:31], v[68:71], v[120:123], v[28:31]
  v_mfma_f32_16x16x32_bf16 v[32:35], v[72:75], v[120:123], v[32:35]
  s_waitcnt vmcnt(0)
  s_barrier
  ds_read_b128 v[36:39], v8 offset:0
  ds_read_b128 v[40:43], v8 offset:1024
  ds_read_b128 v[44:47], v8 offset:2048
  ds_read_b128 v[48:51], v8 offset:3072
  ds_read_b128 v[52:55], v8 offset:4096
  ds_read_b128 v[56:59], v8 offset:5120
  ds_read_b128 v[60:63], v8 offset:6144
  ds_read_b128 v[64:67], v8 offset:7168
  ds_read_b128 v[68:71], v8 offset:8192
  ds_read_b128 v[72:75], v8 offset:9216
  s_waitcnt lgkmcnt(5)
  v_mfma_f32_16x16x32_bf16 v[16:19], v[36:39], v[76:79], v[16:19]
  v_mfma_f32_16x16x32_bf16 v[20:23], v[40:43], v[76:79], v[20:23]
  v_mfma_f32_16x16x32_bf16 v[24:27], v[44:47], v[76:79], v[24:27]
  v_mfma_f32_16x16x32_bf16 v[28:31], v[48:51], v[76:79], v[28:31]
  v_mfma_f32_16x16x32_bf16 v[32:35], v[52:55], v[76:79], v[32:35]
  ds_read_b128 v[36:39], v8 offset:10240
  ds_read_b128 v[40:43], v8 offset:11264
  ds_read_b128 v[44:47], v8 offset:12288
  ds_read_b128 v[48:51], v8 offset:13312
  ds_read_b128 v[52:55], v8 offset:14336
  s_waitcnt lgkmcnt(5)
  v_mfma_f32_16x16x32_bf16 v[16:19], v[56:59], v[80:83], v[16:19]
  v_mfma_f32_16x16x32_bf16 v[20:23], v[60:63], v[80:83], v[20:23]
  v_mfma_f32_16x16x32_bf16 v[24:27], v[64:67], v[80:83], v[24:27]
  v_mfma_f32_16x16x32_bf16 v[28:31], v[68:71], v[80:83], v[28:31]
  v_mfma_f32_16x16x32_bf16 v[32:35], v[72:75], v[80:83], v[32:35]
  ds_read_b128 v[56:59], v8 offset:15360
  ds_read_b128 v[60:63], v8 offset:16384
  ds_read_b128 v[64:67], v8 offset:17408
  ds_read_b128 v[68:71], v8 offset:18432
  ds_read_b128 v[72:75], v8 offset:19456
  s_waitcnt lgkmcnt(5)
  v_mfma_f32_16x16x32_bf16 v[16:19], v[36:39], v[84:87], v[16:19]
  v_mfma_f32_16x16x32_bf16 v[20:23], v[40:43], v[84:87], v[20:23]
  v_mfma_f32_16x16x32_bf16 v[24:27], v[44:47], v[84:87], v[24:27]
  v_mfma_f32_16x16x32_bf16 v[28:31], v[48:51], v[84:87], v[28:31]
  v_mfma_f32_16x16x32_bf16 v[32:35], v[52:55], v[84:87], v[32:35]
  s_waitcnt lgkmcnt(0)
  v_mfma_f32_16x16x32_bf16 v[16:19], v[56:59], v[88:91], v[16:19]
  v_mfma_f32_16x16x32_bf16 v[20:23], v[60:63], v[88:91], v[20:23]
  v_mfma_f32_16x16x32_bf16 v[24:27], v[64:67], v[88:91], v[24:27]
  v_mfma_f32_16x16x32_bf16 v[28:31], v[68:71], v[88:91], v[28:31]
  v_mfma_f32_16x16x32_bf16 v[32:35], v[72:75], v[88:91], v[32:35]
  s_nop 7
  v_cvt_pk_bf16_f32 v36, v16, v17
  v_cvt_pk_bf16_f32 v37, v18, v19
  v_cvt_pk_bf16_f32 v38, v20, v21
  v_cvt_pk_bf16_f32 v39, v22, v23
  v_cvt_pk_bf16_f32 v40, v24, v25
  v_cvt_pk_bf16_f32 v41, v26, v27
  v_cvt_pk_bf16_f32 v42, v28, v29
  v_cvt_pk_bf16_f32 v43, v30, v31
  v_cvt_pk_bf16_f32 v44, v32, v33
  v_cvt_pk_bf16_f32 v45, v34, v35
  buffer_store_dwordx4 v[36:39], v9, s[12:15], s19 offen
  buffer_store_dwordx4 v[40:43], v9, s[12:15], s19 offen offset:64
  buffer_store_dwordx2 v[44:45], v5, s[12:15], s19 offen offset:128
Lout_end:
  s_endpgm
.section .rodata,"a"
.p2align 6
.amdhsa_kernel proj_kernel
  .amdhsa_next_free_vgpr 144
  .amdhsa_next_free_sgpr 96
  .amdhsa_accum_offset 144
  .amdhsa_group_segment_fixed_size 0
  .amdhsa_kernarg_size 96
  .amdhsa_user_sgpr_count 2
  .amdhsa_user_sgpr_kernarg_segment_ptr 1
  .amdhsa_system_sgpr_workgroup_id_x 1
.end_amdhsa_kernel
.p2align 6
.amdhsa_kernel attn_kernel
  .amdhsa_next_free_vgpr 112
  .amdhsa_next_free_sgpr 96
  .amdhsa_accum_offset 112
  .amdhsa_group_segment_fixed_size 0
  .amdhsa_kernarg_size 96
  .amdhsa_user_sgpr_count 2
  .amdhsa_user_sgpr_kernarg_segment_ptr 1
  .amdhsa_system_sgpr_workgroup_id_x 1
.end_amdhsa_kernel
.p2align 6
.amdhsa_kernel out_kernel
  .amdhsa_next_free_vgpr 124
  .amdhsa_next_free_sgpr 96
  .amdhsa_accum_offset 124
  .amdhsa_group_segment_fixed_size 0
  .amdhsa_kernarg_size 96
  .amdhsa_user_sgpr_count 2
  .amdhsa_user_sgpr_kernarg_segment_ptr 1
  .amdhsa_system_sgpr_workgroup_id_x 1
.end_amdhsa_kernel
```
